```python
import torch

def _softmax(x, axis=-1):
    return torch.softmax(x, dim=axis)
def _gelu(x):
    return torch.nn.functional.gelu(x, approximate="tanh")
def _silu(x):
    return torch.nn.functional.silu(x)
def _sigmoid(x):
    return torch.sigmoid(x)
def _layernorm(x, axis=-1, eps=1e-5):
    m = x.mean(dim=axis, keepdim=True)
    v = x.var(dim=axis, keepdim=True, unbiased=False)
    return (x - m) / torch.sqrt(v + eps)
def _scatter_add(tgt, idx, src, axis=0):
    return tgt.clone().index_add_(axis, idx, src)
def _segment_sum(src, seg, n):
    out = torch.zeros((n,) + src.shape[1:], dtype=src.dtype)
    return out.index_add_(0, seg, src)
def _pad(x, pw):
    flat = tuple(v for pair in reversed(pw) for v in pair)
    return torch.nn.functional.pad(x, flat)

kernel_name = 'parallel_sum__softmax_full_mha__dense_activation_mish__prompt'

def setup_inputs():

    _w = (lambda a: (lambda t: t.to(torch.bfloat16) if t.is_floating_point() else t)(torch.as_tensor(a)))
    def _A_setup():
        B, S, D = 1, 2048, 512
        return {
            "x": _w((lambda *s: torch.randn(*s, dtype=torch.bfloat16) * 0.05)(B, S, D)),
            "wqkv": _w((lambda *s: torch.randn(*s, dtype=torch.bfloat16) * 0.05)(D, 3 * D)),
            "wo": _w((lambda *s: torch.randn(*s, dtype=torch.bfloat16) * 0.05)(D, D)),
        }
    _A_in = _A_setup()

    def _B_setup():
        B, S, D, F = 1, 2048, 512, 1792
        return {
            "x": _w((lambda *s: torch.randn(*s, dtype=torch.bfloat16) * 0.05)(B, S, D)),
            "w1": _w((lambda *s: torch.randn(*s, dtype=torch.bfloat16) * 0.8)(D, F) * (D ** -0.5)),
            "b1": _w((lambda *s: torch.randn(*s, dtype=torch.bfloat16) * 0.8)(F)),
            "w2": _w((lambda *s: torch.randn(*s, dtype=torch.bfloat16) * 0.2)(F, D) * (F ** -0.5)),
        }
    _B_in = _B_setup()

    return {
        "A_x": _A_in["x"],
        "A_wqkv": _A_in["wqkv"],
        "A_wo": _A_in["wo"],
        "B_x": _B_in["x"],
        "B_w1": _B_in["w1"],
        "B_b1": _B_in["b1"],
        "B_w2": _B_in["w2"],
    }

def reference(A_x, A_wqkv, A_wo, B_x, B_w1, B_b1, B_w2):
    def _A_ref(x, wqkv, wo):
        B, S, D = x.shape
        H = 32; Dh = D // H
        qkv = (lambda x, *d: x.permute(*d))((x @ wqkv).reshape(B, S, 3, H, Dh), 2, 0, 3, 1, 4)
        q, k, v = qkv[0], qkv[1], qkv[2]
        scale = Dh ** -0.5
        scores = torch.einsum("bhqd,bhkd->bhqk", q, k) * scale
        p = _softmax(scores, axis=-1)
        o = torch.einsum("bhqk,bhkd->bhqd", p, v)
        return (lambda x, *d: x.permute(*d))(o, 0, 2, 1, 3).reshape(B, S, D) @ wo

    def _B_ref(x, w1, b1, w2):
        h = torch.einsum("bsd,df->bsf", x, w1) + b1
        sp = torch.log1p(torch.exp(-torch.abs(h))) + torch.where(h > 0, h, torch.zeros_like(h))
        act = h * torch.tanh(sp)
        return torch.einsum("bsf,fd->bsd", act, w2)

    x = A_x
    xn = _layernorm(x, axis=-1)
    return x + _A_ref(xn, A_wqkv, A_wo) + _B_ref(xn, B_w1, B_b1, B_w2)
```

```asm
; @launch grid=(256,1,1) block=(512,1,1) lds=153856
.amdgcn_target "amdgcn-amd-amdhsa--gfx950"
.text
.globl parallel_sum__softmax_full_mha__dense_activation_mish__prompt_kernel
.p2align 8
.type parallel_sum__softmax_full_mha__dense_activation_mish__prompt_kernel,@function
parallel_sum__softmax_full_mha__dense_activation_mish__prompt_kernel:
  s_cmp_ge_u32 s2, 256
  s_cbranch_scc1 k1_end
  s_load_dwordx16 s[36:51], s[0:1], 0
  s_load_dwordx4 s[52:55], s[0:1], 64
  v_lshrrev_b32 v1, 6, v0
  v_and_b32 v0, 63, v0
  v_readfirstlane_b32 s56, v1
  v_lshlrev_b32 v16, 4, v0
  s_and_b32 s72, s2, 7
  s_lshr_b32 s73, s2, 3
  s_and_b32 s59, s72, 1
  s_lshl_b32 s59, s59, 3
  s_and_b32 s74, s73, 7
  s_add_u32 s59, s59, s74
  s_lshr_b32 s74, s72, 1
  s_lshl_b32 s74, s74, 2
  s_lshr_b32 s75, s73, 3
  s_add_u32 s74, s74, s75
  s_and_b32 s61, s74, 1
  s_lshr_b32 s60, s74, 1
  s_and_b32 s57, s56, 3
  s_lshr_b32 s58, s56, 2
  s_lshl_b32 s62, s59, 2
  s_add_u32 s62, s62, s57
  v_lshrrev_b32 v24, 3, v0
  v_and_b32 v25, 7, v0
  v_lshrrev_b32 v26, 4, v0
  v_xor_b32 v27, v25, v26
  v_lshlrev_b32 v27, 4, v27
  v_lshl_add_u32 v2, v24, 10, v27
  v_xor_b32 v3, 64, v2
  v_add_u32 v3, 7168, v3
  v_and_b32 v26, 1, v26
  v_lshlrev_b32 v26, 2, v26
  v_xor_b32 v27, v25, v26
  v_lshlrev_b32 v27, 4, v27
  s_lshr_b32 s72, s60, 1
  s_mul_i32 s72, s72, 896
  s_and_b32 s73, s60, 1
  s_lshl_b32 s74, s73, 9
  s_add_u32 s74, s74, s72
  s_add_u32 s75, s72, 384
  s_mov_b32 s81, s74
  s_mov_b32 s82, s75
  s_lshl_b32 s76, s60, 7
  s_lshl_b32 s77, s58, 10
  s_add_u32 s77, s77, s76
  s_add_u32 s78, s76, 2048
  s_add_u32 s79, s74, 128
  s_cmp_eq_u32 s58, 0
  s_cselect_b32 s78, s78, s79
  s_cmp_eq_u32 s61, 0
  s_cselect_b32 s77, s77, s78
  s_and_b32 s78, s61, s58
  s_cmp_eq_u32 s78, 1
  s_movk_i32 s79, 3072
  s_cselect_b32 s79, 3584, s79
  s_lshl_b32 s67, s79, 6
  s_lshl_b32 s65, s57, 4
  s_mul_i32 s65, s65, s79
  s_add_u32 s65, s65, s77
  v_mul_lo_u32 v28, v24, s79
  v_add_u32 v4, v28, v27
  s_lshl_b32 s79, s79, 3
  s_sub_u32 s79, s79, 1024
  v_add_u32 v5, s79, v4
  s_lshl_b32 s64, s56, 11
  s_lshl_b32 s66, s57, 11
  s_lshl_b32 s79, s58, 13
  s_add_u32 s66, s66, s79
  s_mov_b32 s69, s64
  s_lshl_b32 s63, s59, 17
  s_lshl_b32 s79, s56, 14
  s_add_u32 s63, s63, s79
  s_waitcnt lgkmcnt(0)
  s_mov_b32 s8, s36
  s_and_b32 s9, s37, 0xffff
  s_mov_b32 s10, 2097152
  s_mov_b32 s11, 0x00020000
  s_cmp_eq_u32 s78, 1
  s_cselect_b32 s12, s44, s38
  s_cselect_b32 s13, s45, s39
  s_mov_b32 s14, 1572864
  s_cselect_b32 s14, 1835008, s14
  s_and_b32 s13, s13, 0xffff
  s_mov_b32 s15, 0x00020000
  s_add_u32 m0, s64, 0
  s_nop 0
  buffer_load_dwordx4 v2, s[8:11], s63 offen lds
  buffer_load_dwordx4 v3, s[8:11], s63 offen offset:1024 lds
  s_add_u32 s63, s63, 128
  s_add_u32 m0, s66, 65536
  s_nop 0
  buffer_load_dwordx4 v4, s[12:15], s65 offen lds
  buffer_load_dwordx4 v5, s[12:15], s65 offen offset:1024 lds
  s_add_u32 s65, s65, s67
  s_barrier
  s_mov_b32 s4, s52
  s_and_b32 s5, s53, 0xffff
  s_mov_b32 s6, 256
  s_mov_b32 s7, 0x00020000
  s_lshl_b32 s72, s2, 3
  s_add_u32 s72, s72, s56
  s_lshl_b32 s72, s72, 10
  buffer_load_dwordx4 v[32:35], v16, s[8:11], s72 offen
  s_lshr_b32 s73, s2, 2
  s_and_b32 s74, s2, 3
  s_cmp_lt_u32 s73, 24
  s_cselect_b32 s28, s38, s44
  s_cselect_b32 s29, s39, s45
  s_mov_b32 s30, 1835008
  s_cselect_b32 s30, 1572864, s30
  s_movk_i32 s75, 3584
  s_cselect_b32 s75, 3072, s75
  s_cselect_b32 s76, 0, 24
  s_and_b32 s29, s29, 0xffff
  s_mov_b32 s31, 0x00020000
  s_sub_u32 s76, s73, s76
  s_lshl_b32 s76, s76, 7
  s_lshl_b32 s77, s74, 7
  s_lshl_b32 s74, s56, 4
  s_add_u32 s77, s77, s74
  s_mul_i32 s77, s77, s75
  s_add_u32 s77, s77, s76
  s_cmp_lt_u32 s2, 208
  s_cselect_b32 s77, s77, 0x20000000
  v_mul_lo_u32 v28, v24, s75
  v_add_u32 v28, v28, v27
  s_lshl_b32 s75, s75, 3
  s_sub_u32 s75, s75, 1024
  v_add_u32 v29, s75, v28
  s_add_u32 m0, s64, 137472
  s_nop 0
  buffer_load_dwordx4 v28, s[28:31], s77 offen lds
  buffer_load_dwordx4 v29, s[28:31], s77 offen offset:1024 lds
  s_or_b32 s73, s2, s56
  s_cmp_eq_u32 s73, 0
  s_cbranch_scc0 k1_nn
  s_memrealtime s[94:95]
  s_waitcnt lgkmcnt(0)
  s_or_b32 s94, s94, 1
  v_mov_b32 v28, s94
  v_mov_b32 v29, 0
  buffer_store_dword v28, v29, s[4:7], 0 offen sc1
  s_waitcnt vmcnt(0)
k1_nn:
  s_add_u32 m0, s64, 16384
  s_nop 0
  buffer_load_dwordx4 v2, s[8:11], s63 offen lds
  buffer_load_dwordx4 v3, s[8:11], s63 offen offset:1024 lds
  s_add_u32 s63, s63, 128
  s_add_u32 m0, s66, 81920
  s_nop 0
  buffer_load_dwordx4 v4, s[12:15], s65 offen lds
  buffer_load_dwordx4 v5, s[12:15], s65 offen offset:1024 lds
  s_add_u32 s65, s65, s67
  s_movk_i32 s72, 3584
  v_mul_lo_u32 v28, v24, s72
  v_add_u32 v6, v28, v27
  v_add_u32 v7, 27648, v6
  s_mul_i32 s79, s56, 57344
  s_add_u32 s77, s81, 256
  s_cmp_eq_u32 s61, 0
  s_cselect_b32 s68, s81, s77
  s_cselect_b32 s70, s82, 0x10000000
  s_add_u32 s68, s68, s79
  s_add_u32 s70, s70, s79
  v_and_b32 v24, 31, v0
  v_lshrrev_b32 v25, 5, v0
  v_lshrrev_b32 v26, 1, v24
  v_and_b32 v26, 7, v26
  v_xor_b32 v26, v26, v25
  s_lshl_b32 s72, s57, 12
  v_lshlrev_b32 v27, 7, v24
  v_add_u32 v27, s72, v27
  v_xor_b32 v28, 0, v26
  v_lshl_add_u32 v8, v28, 4, v27
  v_xor_b32 v28, 2, v26
  v_lshl_add_u32 v9, v28, 4, v27
  v_xor_b32 v28, 4, v26
  v_lshl_add_u32 v10, v28, 4, v27
  v_xor_b32 v28, 6, v26
  v_lshl_add_u32 v11, v28, 4, v27
  v_lshrrev_b32 v26, 4, v0
  v_and_b32 v27, 1, v26
  v_lshrrev_b32 v26, 1, v26
  v_and_b32 v28, 15, v0
  v_lshrrev_b32 v29, 2, v28
  v_and_b32 v28, 3, v28
  v_lshl_add_u32 v30, v26, 3, v29
  v_lshlrev_b32 v30, 7, v30
  v_lshl_add_u32 v30, v27, 5, v30
  v_lshl_add_u32 v30, v28, 3, v30
  v_lshrrev_b32 v29, 1, v29
  v_and_b32 v29, 1, v29
  v_lshl_add_u32 v30, v29, 6, v30
  v_add_u32 v14, 65536, v30
  v_xor_b32 v15, 64, v14
  s_lshl_b32 s72, s58, 13
  v_add_u32 v12, s72, v14
  v_add_u32 v13, s72, v15
  v_mov_b32 v22, 0
  v_and_b32 v24, 15, v0
  v_bfe_u32 v25, v0, 4, 1
  v_cmp_eq_u32 vcc, v24, v25
  v_mov_b32 v26, 0x3f803f80
  v_mov_b32 v27, 0
  v_cndmask_b32 v56, v27, v26, vcc
  v_cndmask_b32 v57, v27, v26, vcc
  v_cndmask_b32 v58, v27, v26, vcc
  v_cndmask_b32 v59, v27, v26, vcc
  v_mov_b32 v64, 0
  v_mov_b32 v65, 0
  v_mov_b32 v66, 0
  v_mov_b32 v67, 0
  v_mov_b32 v68, 0
  v_mov_b32 v69, 0
  v_mov_b32 v70, 0
  v_mov_b32 v71, 0
  v_mov_b32 v72, 0
  v_mov_b32 v73, 0
  v_mov_b32 v74, 0
  v_mov_b32 v75, 0
  v_mov_b32 v76, 0
  v_mov_b32 v77, 0
  v_mov_b32 v78, 0
  v_mov_b32 v79, 0
  v_mov_b32 v80, 0
  v_mov_b32 v81, 0
  v_mov_b32 v82, 0
  v_mov_b32 v83, 0
  v_mov_b32 v84, 0
  v_mov_b32 v85, 0
  v_mov_b32 v86, 0
  v_mov_b32 v87, 0
  v_mov_b32 v88, 0
  v_mov_b32 v89, 0
  v_mov_b32 v90, 0
  v_mov_b32 v91, 0
  v_mov_b32 v92, 0
  v_mov_b32 v93, 0
  v_mov_b32 v94, 0
  v_mov_b32 v95, 0
  v_mov_b32 v24, 137216
  v_mov_b32 v25, 0
  ds_write_b32 v24, v25
  s_mov_b32 s16, s44
  s_and_b32 s17, s45, 0xffff
  s_mov_b32 s18, 1835008
  s_mov_b32 s19, 0x00020000
  s_mov_b32 s20, s54
  s_and_b32 s21, s55, 0xffff
  s_mov_b32 s22, 268435456
  s_mov_b32 s23, 0x00020000
  s_mov_b32 s24, s46
  s_and_b32 s25, s47, 0xffff
  s_mov_b32 s26, 3584
  s_mov_b32 s27, 0x00020000
  s_add_u32 s72, s81, 128
  s_add_u32 s73, s81, 256
  s_cmp_eq_u32 s61, 0
  s_cselect_b32 s73, s81, s73
  s_cmp_lt_u32 s56, 4
  s_cselect_b32 s72, s72, s73
  s_and_b32 s73, s56, 1
  s_lshl_b32 s73, s73, 6
  s_add_u32 s72, s72, s73
  s_and_b32 s73, s60, 1
  s_lshl_b32 s73, s73, 6
  s_add_u32 s73, s73, s82
  s_cmp_ge_u32 s56, 6
  s_cselect_b32 s72, s73, s72
  s_mov_b32 s32, s72
  s_lshr_b32 s72, s81, 7
  s_add_u32 s72, s72, 24
  s_lshr_b32 s73, s82, 7
  s_add_u32 s73, s73, 24
  s_add_u32 s74, s60, 8
  s_add_u32 s75, s60, 16
  s_add_u32 s76, s72, 1
  s_add_u32 s77, s72, 2
  s_cmp_eq_u32 s61, 0
  s_cselect_b32 s34, s60, s75
  s_cselect_b32 s35, s74, s76
  s_cselect_b32 s42, s72, s77
  s_cselect_b32 s43, s73, s77
  v_and_b32 v21, 31, v0
  v_lshlrev_b32 v21, 1, v21
  v_min_u32 v24, 31, v0
  v_subrev_u32 v25, 16, v24
  v_lshrrev_b32 v26, 2, v25
  v_mov_b32 v27, s34
  v_cmp_eq_u32 vcc, 1, v26
  v_mov_b32 v31, s35
  s_nop 0
  v_cndmask_b32 v27, v27, v31, vcc
  v_cmp_eq_u32 vcc, 2, v26
  v_mov_b32 v31, s42
  s_nop 0
  v_cndmask_b32 v27, v27, v31, vcc
  v_cmp_eq_u32 vcc, 3, v26
  v_mov_b32 v31, s43
  s_nop 0
  v_cndmask_b32 v27, v27, v31, vcc
  v_and_b32 v25, 3, v25
  v_lshl_add_u32 v27, v27, 2, v25
  s_lshl_b32 s73, s59, 4
  v_add_u32 v31, s73, v24
  v_cmp_gt_u32 vcc, 16, v24
  s_nop 1
  v_cndmask_b32 v27, v27, v31, vcc
  v_lshlrev_b32 v46, 2, v27
  v_add_u32 v46, 20987904, v46
  s_and_b32 s73, s56, 1
  s_lshl_b32 s73, s73, 10
  s_lshl_b32 s74, s59, 11
  s_add_u32 s73, s73, s74
  s_add_u32 s92, s73, 21004288
  s_cmp_eq_u32 s57, 1
  s_cselect_b32 s73, s35, s34
  s_cmp_eq_u32 s57, 2
  s_cselect_b32 s73, s42, s73
  s_cmp_eq_u32 s57, 3
  s_cselect_b32 s73, s43, s73
  s_cselect_b32 s74, 1, 0
  s_and_b32 s74, s74, s60
  s_lshl_b32 s74, s74, 7
  s_lshl_b32 s73, s73, 10
  s_add_u32 s73, s73, s74
  s_add_u32 s93, s73, 21069824
  v_lshlrev_b32 v47, 2, v0
  s_add_u32 m0, s64, 32768
  s_nop 0
  buffer_load_dwordx4 v2, s[8:11], s63 offen lds
  buffer_load_dwordx4 v3, s[8:11], s63 offen offset:1024 lds
  s_add_u32 s63, s63, 128
  s_add_u32 m0, s66, 98304
  s_nop 0
  buffer_load_dwordx4 v4, s[12:15], s65 offen lds
  buffer_load_dwordx4 v5, s[12:15], s65 offen offset:1024 lds
  s_add_u32 s65, s65, s67
  s_cmp_eq_u32 s58, 1
  s_cbranch_scc1 k1_T1
  s_cmp_eq_u32 s61, 1
  s_cbranch_scc1 k1_N
  s_waitcnt vmcnt(11)
  s_barrier
  ds_read_b128 v[128:131], v8 offset:0
  ds_read_b64_tr_b16 v[96:97], v12 offset:0
  ds_read_b64_tr_b16 v[98:99], v12 offset:512
  ds_read_b64_tr_b16 v[100:101], v13 offset:0
  ds_read_b64_tr_b16 v[102:103], v13 offset:512
  ds_read_b128 v[132:135], v9 offset:0
  ds_read_b64_tr_b16 v[104:105], v12 offset:2048
  ds_read_b64_tr_b16 v[106:107], v12 offset:2560
  ds_read_b64_tr_b16 v[108:109], v13 offset:2048
  ds_read_b64_tr_b16 v[110:111], v13 offset:2560
  s_waitcnt lgkmcnt(5)
  v_mfma_f32_32x32x16_bf16 v[64:79], v[96:99], v[128:131], v[64:79]
  ds_read_b128 v[136:139], v10 offset:0
  ds_read_b64_tr_b16 v[112:113], v12 offset:4096
  ds_read_b64_tr_b16 v[114:115], v12 offset:4608
  v_mfma_f32_32x32x16_bf16 v[80:95], v[100:103], v[128:131], v[80:95]
  ds_read_b64_tr_b16 v[116:117], v13 offset:4096
  ds_read_b64_tr_b16 v[118:119], v13 offset:4608
  s_waitcnt lgkmcnt(5)
  v_mfma_f32_32x32x16_bf16 v[64:79], v[104:107], v[132:135], v[64:79]
  ds_read_b128 v[140:143], v11 offset:0
  ds_read_b64_tr_b16 v[120:121], v12 offset:6144
  ds_read_b64_tr_b16 v[122:123], v12 offset:6656
  v_mfma_f32_32x32x16_bf16 v[80:95], v[108:111], v[132:135], v[80:95]
  ds_read_b64_tr_b16 v[124:125], v13 offset:6144
  ds_read_b64_tr_b16 v[126:127], v13 offset:6656
  s_waitcnt lgkmcnt(5)
  s_waitcnt vmcnt(4)
  s_barrier
  s_lshl_b32 s73, s56, 11
  s_add_u32 s73, s73, 71936
  v_add_u32 v24, s73, v14
  v_add_u32 v25, s73, v15
  ds_read_b64_tr_b16 v[60:61], v24 offset:0
  ds_read_b64_tr_b16 v[62:63], v24 offset:512
  ds_read_b64_tr_b16 v[28:29], v25 offset:0
  ds_read_b64_tr_b16 v[30:31], v25 offset:512
  v_mfma_f32_32x32x16_bf16 v[64:79], v[112:115], v[136:139], v[64:79]
  s_add_u32 m0, s64, 49152
  ds_read_b128 v[144:147], v8 offset:16384
  ds_read_b64_tr_b16 v[96:97], v12 offset:16384
  ds_read_b64_tr_b16 v[98:99], v12 offset:16896
  v_mfma_f32_32x32x16_bf16 v[80:95], v[116:119], v[136:139], v[80:95]
  ds_read_b64_tr_b16 v[100:101], v13 offset:16384
  ds_read_b64_tr_b16 v[102:103], v13 offset:16896
  buffer_load_dwordx4 v2, s[8:11], s63 offen lds
  v_lshlrev_b32 v36, 16, v32
  v_and_b32 v37, 0xffff0000, v32
  v_lshlrev_b32 v38, 16, v33
  v_and_b32 v39, 0xffff0000, v33
  v_lshlrev_b32 v40, 16, v34
  v_and_b32 v41, 0xffff0000, v34
  v_lshlrev_b32 v42, 16, v35
  v_and_b32 v43, 0xffff0000, v35
  v_add_f32 v44, v36, v37
  v_mul_f32 v45, v36, v36
  v_fma_f32 v45, v37, v37, v45
  v_add_f32 v44, v44, v38
  v_fma_f32 v45, v38, v38, v45
  v_add_f32 v44, v44, v39
  v_fma_f32 v45, v39, v39, v45
  s_waitcnt lgkmcnt(9)
  v_mfma_f32_32x32x16_bf16 v[64:79], v[120:123], v[140:143], v[64:79]
  ds_read_b128 v[148:151], v9 offset:16384
  ds_read_b64_tr_b16 v[104:105], v12 offset:18432
  ds_read_b64_tr_b16 v[106:107], v12 offset:18944
  v_mfma_f32_32x32x16_bf16 v[80:95], v[124:127], v[140:143], v[80:95]
  ds_read_b64_tr_b16 v[108:109], v13 offset:18432
  ds_read_b64_tr_b16 v[110:111], v13 offset:18944
  buffer_load_dwordx4 v3, s[8:11], s63 offen offset:1024 lds
  s_add_u32 s63, s63, 128
  v_add_f32 v44, v44, v40
  v_fma_f32 v45, v40, v40, v45
  v_add_f32 v44, v44, v41
  v_fma_f32 v45, v41, v41, v45
  v_add_f32 v44, v44, v42
  v_fma_f32 v45, v42, v42, v45
  v_add_f32 v44, v44, v43
  v_fma_f32 v45, v43, v43, v45
  s_nop 1
  v_add_f32_dpp v44, v44, v44 row_ror:8 row_mask:0xf bank_mask:0xf
  v_add_f32_dpp v45, v45, v45 row_ror:8 row_mask:0xf bank_mask:0xf
  s_nop 1
  v_add_f32_dpp v44, v44, v44 row_ror:4 row_mask:0xf bank_mask:0xf
  v_add_f32_dpp v45, v45, v45 row_ror:4 row_mask:0xf bank_mask:0xf
  s_nop 1
  v_mov_b32 v23, 0
  buffer_load_dword v23, v23, s[4:7], 0 offen sc1
  s_waitcnt lgkmcnt(5)
  v_mfma_f32_16x16x32_bf16 v[48:51], v[60:63], v[56:59], 0
  v_mfma_f32_16x16x32_bf16 v[52:55], v[28:31], v[56:59], 0
  v_mfma_f32_32x32x16_bf16 v[64:79], v[96:99], v[144:147], v[64:79]
  s_add_u32 m0, s66, 114688
  ds_read_b128 v[152:155], v10 offset:16384
  ds_read_b64_tr_b16 v[112:113], v12 offset:20480
  ds_read_b64_tr_b16 v[114:115], v12 offset:20992
  v_mfma_f32_32x32x16_bf16 v[80:95], v[100:103], v[144:147], v[80:95]
  ds_read_b64_tr_b16 v[116:117], v13 offset:20480
  ds_read_b64_tr_b16 v[118:119], v13 offset:20992
  buffer_load_dwordx4 v4, s[12:15], s65 offen lds
  v_add_f32_dpp v44, v44, v44 row_ror:2 row_mask:0xf bank_mask:0xf
  v_add_f32_dpp v45, v45, v45 row_ror:2 row_mask:0xf bank_mask:0xf
  s_nop 1
  v_add_f32_dpp v44, v44, v44 row_ror:1 row_mask:0xf bank_mask:0xf
  v_add_f32_dpp v45, v45, v45 row_ror:1 row_mask:0xf bank_mask:0xf
  v_mov_b32 v36, v44
  v_mov_b32 v37, v45
  s_nop 1
  v_permlane16_swap_b32 v44, v36
  v_permlane16_swap_b32 v45, v37
  s_nop 1
  v_add_f32 v44, v44, v36
  v_add_f32 v45, v45, v37
  v_mov_b32 v36, v44
  v_mov_b32 v37, v45
  v_and_b32 v27, 15, v0
  v_lshrrev_b32 v26, 4, v0
  v_lshlrev_b32 v26, 7, v26
  v_lshl_add_u32 v26, v27, 9, v26
  s_lshl_b32 s73, s56, 2
  s_add_u32 s73, s73, 135168
  v_add_u32 v26, s73, v26
  v_cmp_gt_u32 vcc, 2, v27
  s_and_saveexec_b64 s[74:75], vcc
  ds_write_b32 v26, v48 offset:0
  ds_write_b32 v26, v49 offset:32
  ds_write_b32 v26, v50 offset:64
  ds_write_b32 v26, v51 offset:96
  ds_write_b32 v26, v52 offset:1024
  ds_write_b32 v26, v53 offset:1056
  ds_write_b32 v26, v54 offset:1088
  ds_write_b32 v26, v55 offset:1120
  s_mov_b64 exec, s[74:75]
  buffer_load_ushort v21, v21, s[24:27], s32 offen
  s_waitcnt lgkmcnt(13)
  v_mfma_f32_32x32x16_bf16 v[64:79], v[104:107], v[148:151], v[64:79]
  ds_read_b128 v[156:159], v11 offset:16384
  ds_read_b64_tr_b16 v[120:121], v12 offset:22528
  ds_read_b64_tr_b16 v[122:123], v12 offset:23040
  v_mfma_f32_32x32x16_bf16 v[80:95], v[108:111], v[148:151], v[80:95]
  ds_read_b64_tr_b16 v[124:125], v13 offset:22528
  ds_read_b64_tr_b16 v[126:127], v13 offset:23040
  buffer_load_dwordx4 v5, s[12:15], s65 offen offset:1024 lds
  s_add_u32 s65, s65, s67
  s_nop 1
  v_permlane32_swap_b32 v44, v36
  v_permlane32_swap_b32 v45, v37
  s_nop 1
  v_add_f32 v44, v44, v36
  v_add_f32 v45, v45, v37
  v_mul_f32 v44, 0x3b000000, v44
  v_mul_f32 v45, 0x3b000000, v45
  v_fma_f32 v45, -v44, v44, v45
  v_max_f32 v45, 0, v45
  v_add_f32 v45, 0x3727c5ac, v45
  v_rsq_f32 v32, v45
  v_sub_f32 v33, 0, v44
  v_mul_f32 v34, v33, v32
  v_mov_b32 v35, 0
  s_lshl_b32 s73, s2, 3
  s_add_u32 s73, s73, s56
  s_lshl_b32 s73, s73, 4
  s_add_u32 s73, s73, 21004288
  v_mov_b32 v24, 0
  s_mov_b64 exec, 1
  buffer_store_dwordx4 v[32:35], v24, s[20:23], s73 offen sc1
  s_mov_b64 exec, -1
  s_waitcnt lgkmcnt(13)
  s_waitcnt lgkmcnt(5)
  s_waitcnt vmcnt(7)
  s_barrier
  v_lshlrev_b32 v24, 5, v0
  v_add_u32 v24, 135168, v24
  ds_read_b128 v[48:51], v24
  ds_read_b128 v[52:55], v24 offset:16
  v_mfma_f32_32x32x16_bf16 v[64:79], v[112:115], v[152:155], v[64:79]
  s_add_u32 m0, s64, 0
  ds_read_b128 v[160:163], v8 offset:32768
  ds_read_b64_tr_b16 v[96:97], v12 offset:32768
  ds_read_b64_tr_b16 v[98:99], v12 offset:33280
  v_mfma_f32_32x32x16_bf16 v[80:95], v[116:119], v[152:155], v[80:95]
  ds_read_b64_tr_b16 v[100:101], v13 offset:32768
  ds_read_b64_tr_b16 v[102:103], v13 offset:33280
  buffer_load_dwordx4 v2, s[8:11], s63 offen lds
  s_waitcnt lgkmcnt(7)
  v_mfma_f32_32x32x16_bf16 v[64:79], v[120:123], v[156:159], v[64:79]
  ds_read_b128 v[164:167], v9 offset:32768
  ds_read_b64_tr_b16 v[104:105], v12 offset:34816
  ds_read_b64_tr_b16 v[106:107], v12 offset:35328
  v_mfma_f32_32x32x16_bf16 v[80:95], v[124:127], v[156:159], v[80:95]
  ds_read_b64_tr_b16 v[108:109], v13 offset:34816
  ds_read_b64_tr_b16 v[110:111], v13 offset:35328
  buffer_load_dwordx4 v3, s[8:11], s63 offen offset:1024 lds
  s_add_u32 s63, s63, 128
  s_waitcnt lgkmcnt(10)
  v_add_f32 v48, v48, v52
  v_add_f32 v49, v49, v53
  v_add_f32 v50, v50, v54
  v_add_f32 v51, v51, v55
  s_lshl_b32 s73, s2, 8
  s_add_u32 s73, s73, 21069824
  s_cmp_lt_u32 s2, 208
  s_cselect_b32 s73, s73, 0x20000000
  v_add_f32 v48, v48, v49
  v_add_f32 v50, v50, v51
  s_cmp_eq_u32 s56, 0
  s_cselect_b32 s73, s73, 0x20000000
  v_lshlrev_b32 v24, 2, v0
  v_add_f32 v48, v48, v50
  buffer_store_dword v48, v24, s[20:23], s73 offen sc1
  s_waitcnt lgkmcnt(5)
  v_mfma_f32_32x32x16_bf16 v[64:79], v[96:99], v[160:163], v[64:79]
  s_add_u32 m0, s66, 65536
  ds_read_b128 v[168:171], v10 offset:32768
  ds_read_b64_tr_b16 v[112:113], v12 offset:36864
  ds_read_b64_tr_b16 v[114:115], v12 offset:37376
  v_mfma_f32_32x32x16_bf16 v[80:95], v[100:103], v[160:163], v[80:95]
  ds_read_b64_tr_b16 v[116:117], v13 offset:36864
  ds_read_b64_tr_b16 v[118:119], v13 offset:37376
  buffer_load_dwordx4 v4, s[12:15], s65 offen lds
  s_waitcnt lgkmcnt(5)
  v_mfma_f32_32x32x16_bf16 v[64:79], v[104:107], v[164:167], v[64:79]
  ds_read_b128 v[172:175], v11 offset:32768
  ds_read_b64_tr_b16 v[120:121], v12 offset:38912
  ds_read_b64_tr_b16 v[122:123], v12 offset:39424
  v_mfma_f32_32x32x16_bf16 v[80:95], v[108:111], v[164:167], v[80:95]
  ds_read_b64_tr_b16 v[124:125], v13 offset:38912
  ds_read_b64_tr_b16 v[126:127], v13 offset:39424
  buffer_load_dwordx4 v5, s[12:15], s65 offen offset:1024 lds
  s_add_u32 s65, s65, s67
  s_waitcnt lgkmcnt(5)
  s_waitcnt vmcnt(6)
  s_barrier
  v_mfma_f32_32x32x16_bf16 v[64:79], v[112:115], v[168:171], v[64:79]
  s_add_u32 m0, s64, 16384
  ds_read_b128 v[176:179], v8 offset:49152
  ds_read_b64_tr_b16 v[96:97], v12 offset:49152
  ds_read_b64_tr_b16 v[98:99], v12 offset:49664
  v_mfma_f32_32x32x16_bf16 v[80:95], v[116:119], v[168:171], v[80:95]
  ds_read_b64_tr_b16 v[100:101], v13 offset:49152
  ds_read_b64_tr_b16 v[102:103], v13 offset:49664
  buffer_load_dwordx4 v2, s[8:11], s63 offen lds
  s_waitcnt lgkmcnt(5)
  v_mfma_f32_32x32x16_bf16 v[64:79], v[120:123], v[172:175], v[64:79]
  ds_read_b128 v[180:183], v9 offset:49152
  ds_read_b64_tr_b16 v[104:105], v12 offset:51200
  ds_read_b64_tr_b16 v[106:107], v12 offset:51712
  v_mfma_f32_32x32x16_bf16 v[80:95], v[124:127], v[172:175], v[80:95]
  ds_read_b64_tr_b16 v[108:109], v13 offset:51200
  ds_read_b64_tr_b16 v[110:111], v13 offset:51712
  buffer_load_dwordx4 v3, s[8:11], s63 offen offset:1024 lds
  s_add_u32 s63, s63, 128
  s_waitcnt lgkmcnt(5)
  v_mfma_f32_32x32x16_bf16 v[64:79], v[96:99], v[176:179], v[64:79]
  s_add_u32 m0, s66, 81920
  ds_read_b128 v[184:187], v10 offset:49152
  ds_read_b64_tr_b16 v[112:113], v12 offset:53248
  ds_read_b64_tr_b16 v[114:115], v12 offset:53760
  v_mfma_f32_32x32x16_bf16 v[80:95], v[100:103], v[176:179], v[80:95]
  ds_read_b64_tr_b16 v[116:117], v13 offset:53248
  ds_read_b64_tr_b16 v[118:119], v13 offset:53760
  buffer_load_dwordx4 v4, s[12:15], s65 offen lds
  s_waitcnt lgkmcnt(5)
  v_mfma_f32_32x32x16_bf16 v[64:79], v[104:107], v[180:183], v[64:79]
  ds_read_b128 v[188:191], v11 offset:49152
  ds_read_b64_tr_b16 v[120:121], v12 offset:55296
  ds_read_b64_tr_b16 v[122:123], v12 offset:55808
  v_mfma_f32_32x32x16_bf16 v[80:95], v[108:111], v[180:183], v[80:95]
  ds_read_b64_tr_b16 v[124:125], v13 offset:55296
  ds_read_b64_tr_b16 v[126:127], v13 offset:55808
  buffer_load_dwordx4 v5, s[12:15], s65 offen offset:1024 lds
  s_add_u32 s65, s65, s67
  s_waitcnt lgkmcnt(5)
  s_waitcnt vmcnt(4)
  s_barrier
  v_readfirstlane_b32 s90, v23
  s_mov_b32 s77, 0
k1_nqT0:
  s_cmp_lg_u32 s90, 0
  s_cbranch_scc1 k1_nokT0
  v_mov_b32 v23, 0
  buffer_load_dword v23, v23, s[4:7], 0 offen sc1
  s_waitcnt vmcnt(0)
  v_readfirstlane_b32 s90, v23
  s_add_u32 s77, s77, 1
  s_cmp_lt_u32 s77, 200000
  s_cbranch_scc1 k1_nqT0
k1_nokT0:
  s_cmp_eq_u32 s56, 0
  s_cbranch_scc0 k1_pfT0
  s_lshl_b32 s73, s2, 2
  s_add_u32 s73, s73, 20987904
  v_mov_b32 v24, s90
  v_mov_b32 v25, 0
  s_mov_b64 exec, 1
  buffer_store_dword v24, v25, s[20:23], s73 offen sc1
  s_mov_b64 exec, -1
k1_pfT0:
  v_mfma_f32_32x32x16_bf16 v[64:79], v[112:115], v[184:187], v[64:79]
  s_add_u32 m0, s64, 32768
  ds_read_b128 v[192:195], v8 offset:0
  ds_read_b64_tr_b16 v[96:97], v12 offset:0
  ds_read_b64_tr_b16 v[98:99], v12 offset:512
  v_mfma_f32_32x32x16_bf16 v[80:95], v[116:119], v[184:187], v[80:95]
  ds_read_b64_tr_b16 v[100:101], v13 offset:0
  ds_read_b64_tr_b16 v[102:103], v13 offset:512
  buffer_load_dwordx4 v2, s[8:11], s63 offen lds
  v_lshlrev_b32 v21, 16, v21
  v_and_b32 v24, 31, v0
  s_lshl_b32 s73, s56, 7
  s_add_u32 s73, s73, 134144
  v_lshl_add_u32 v24, v24, 2, s73
  ds_write_b32 v24, v21
  s_waitcnt lgkmcnt(6)
  v_mfma_f32_32x32x16_bf16 v[64:79], v[120:123], v[188:191], v[64:79]
  ds_read_b128 v[196:199], v9 offset:0
  ds_read_b64_tr_b16 v[104:105], v12 offset:2048
  ds_read_b64_tr_b16 v[106:107], v12 offset:2560
  v_mfma_f32_32x32x16_bf16 v[80:95], v[124:127], v[188:191], v[80:95]
  ds_read_b64_tr_b16 v[108:109], v13 offset:2048
  ds_read_b64_tr_b16 v[110:111], v13 offset:2560
  buffer_load_dwordx4 v3, s[8:11], s63 offen offset:1024 lds
  s_add_u32 s63, s63, 128
  s_waitcnt lgkmcnt(6)
  v_mfma_f32_32x32x16_bf16 v[64:79], v[96:99], v[192:195], v[64:79]
  s_add_u32 m0, s66, 98304
  ds_read_b128 v[200:203], v10 offset:0
  ds_read_b64_tr_b16 v[112:113], v12 offset:4096
  ds_read_b64_tr_b16 v[114:115], v12 offset:4608
  v_mfma_f32_32x32x16_bf16 v[80:95], v[100:103], v[192:195], v[80:95]
  ds_read_b64_tr_b16 v[116:117], v13 offset:4096
  ds_read_b64_tr_b16 v[118:119], v13 offset:4608
  buffer_load_dwordx4 v4, s[12:15], s65 offen lds
  s_waitcnt lgkmcnt(5)
  v_mfma_f32_32x32x16_bf16 v[64:79], v[104:107], v[196:199], v[64:79]
  ds_read_b128 v[204:207], v11 offset:0
  ds_read_b64_tr_b16 v[120:121], v12 offset:6144
  ds_read_b64_tr_b16 v[122:123], v12 offset:6656
  v_mfma_f32_32x32x16_bf16 v[80:95], v[108:111], v[196:199], v[80:95]
  ds_read_b64_tr_b16 v[124:125], v13 offset:6144
  ds_read_b64_tr_b16 v[126:127], v13 offset:6656
  buffer_load_dwordx4 v5, s[12:15], s65 offen offset:1024 lds
  s_add_u32 s65, s65, s67
  s_waitcnt lgkmcnt(5)
  s_waitcnt vmcnt(4)
  s_barrier
  v_mfma_f32_32x32x16_bf16 v[64:79], v[112:115], v[200:203], v[64:79]
  s_add_u32 m0, s64, 49152
  ds_read_b128 v[208:211], v8 offset:16384
  ds_read_b64_tr_b16 v[96:97], v12 offset:16384
  ds_read_b64_tr_b16 v[98:99], v12 offset:16896
  v_mfma_f32_32x32x16_bf16 v[80:95], v[116:119], v[200:203], v[80:95]
  ds_read_b64_tr_b16 v[100:101], v13 offset:16384
  ds_read_b64_tr_b16 v[102:103], v13 offset:16896
  buffer_load_dwordx4 v2, s[8:11], s63 offen lds
  s_waitcnt lgkmcnt(5)
  v_mfma_f32_32x32x16_bf16 v[64:79], v[120:123], v[204:207], v[64:79]
  ds_read_b128 v[212:215], v9 offset:16384
  ds_read_b64_tr_b16 v[104:105], v12 offset:18432
  ds_read_b64_tr_b16 v[106:107], v12 offset:18944
  v_mfma_f32_32x32x16_bf16 v[80:95], v[124:127], v[204:207], v[80:95]
  ds_read_b64_tr_b16 v[108:109], v13 offset:18432
  ds_read_b64_tr_b16 v[110:111], v13 offset:18944
  buffer_load_dwordx4 v3, s[8:11], s63 offen offset:1024 lds
  s_add_u32 s63, s63, 128
  s_waitcnt lgkmcnt(5)
  v_mfma_f32_32x32x16_bf16 v[64:79], v[96:99], v[208:211], v[64:79]
  s_add_u32 m0, s66, 114688
  ds_read_b128 v[216:219], v10 offset:16384
  ds_read_b64_tr_b16 v[112:113], v12 offset:20480
  ds_read_b64_tr_b16 v[114:115], v12 offset:20992
  v_mfma_f32_32x32x16_bf16 v[80:95], v[100:103], v[208:211], v[80:95]
  ds_read_b64_tr_b16 v[116:117], v13 offset:20480
  ds_read_b64_tr_b16 v[118:119], v13 offset:20992
  buffer_load_dwordx4 v4, s[12:15], s65 offen lds
  s_waitcnt lgkmcnt(5)
  v_mfma_f32_32x32x16_bf16 v[64:79], v[104:107], v[212:215], v[64:79]
  ds_read_b128 v[220:223], v11 offset:16384
  ds_read_b64_tr_b16 v[120:121], v12 offset:22528
  ds_read_b64_tr_b16 v[122:123], v12 offset:23040
  v_mfma_f32_32x32x16_bf16 v[80:95], v[108:111], v[212:215], v[80:95]
  ds_read_b64_tr_b16 v[124:125], v13 offset:22528
  ds_read_b64_tr_b16 v[126:127], v13 offset:23040
  buffer_load_dwordx4 v5, s[12:15], s65 offen offset:1024 lds
  s_add_u32 s65, s65, s67
  buffer_load_dword v31, v46, s[20:23], 0 offen sc1
  s_waitcnt lgkmcnt(5)
  s_waitcnt vmcnt(5)
  s_barrier
  v_mfma_f32_32x32x16_bf16 v[64:79], v[112:115], v[216:219], v[64:79]
  s_add_u32 m0, s69, 65536
  ds_read_b128 v[224:227], v8 offset:32768
  ds_read_b64_tr_b16 v[96:97], v12 offset:32768
  ds_read_b64_tr_b16 v[98:99], v12 offset:33280
  v_mfma_f32_32x32x16_bf16 v[80:95], v[116:119], v[216:219], v[80:95]
  ds_read_b64_tr_b16 v[100:101], v13 offset:32768
  ds_read_b64_tr_b16 v[102:103], v13 offset:33280
  buffer_load_dwordx4 v6, s[16:19], s68 offen lds
  s_waitcnt lgkmcnt(5)
  v_mfma_f32_32x32x16_bf16 v[64:79], v[120:123], v[220:223], v[64:79]
  ds_read_b128 v[228:231], v9 offset:32768
  ds_read_b64_tr_b16 v[104:105], v12 offset:34816
  ds_read_b64_tr_b16 v[106:107], v12 offset:35328
  v_mfma_f32_32x32x16_bf16 v[80:95], v[124:127], v[220:223], v[80:95]
  ds_read_b64_tr_b16 v[108:109], v13 offset:34816
  ds_read_b64_tr_b16 v[110:111], v13 offset:35328
  buffer_load_dwordx4 v7, s[16:19], s68 offen offset:1024 lds
  s_add_u32 s68, s68, 458752
  s_waitcnt lgkmcnt(5)
  v_mfma_f32_32x32x16_bf16 v[64:79], v[96:99], v[224:227], v[64:79]
  s_add_u32 m0, s69, 0
  ds_read_b128 v[232:235], v10 offset:32768
  ds_read_b64_tr_b16 v[112:113], v12 offset:36864
  ds_read_b64_tr_b16 v[114:115], v12 offset:37376
  v_mfma_f32_32x32x16_bf16 v[80:95], v[100:103], v[224:227], v[80:95]
  ds_read_b64_tr_b16 v[116:117], v13 offset:36864
  ds_read_b64_tr_b16 v[118:119], v13 offset:37376
  buffer_load_dwordx4 v6, s[16:19], s70 offen lds
  s_waitcnt lgkmcnt(5)
  v_mfma_f32_32x32x16_bf16 v[64:79], v[104:107], v[228:231], v[64:79]
  ds_read_b128 v[236:239], v11 offset:32768
  ds_read_b64_tr_b16 v[120:121], v12 offset:38912
  ds_read_b64_tr_b16 v[122:123], v12 offset:39424
  v_mfma_f32_32x32x16_bf16 v[80:95], v[108:111], v[228:231], v[80:95]
  ds_read_b64_tr_b16 v[124:125], v13 offset:38912
  ds_read_b64_tr_b16 v[126:127], v13 offset:39424
  buffer_load_dwordx4 v7, s[16:19], s70 offen offset:1024 lds
  s_add_u32 s70, s70, 458752
  s_waitcnt lgkmcnt(5)
  s_waitcnt vmcnt(5)
  s_barrier
  s_waitcnt vmcnt(4)
  s_mov_b32 s77, 0
k1_cpT0:
  v_cmp_eq_u32 vcc, s90, v31
  s_add_u32 s77, s77, 1
  s_cmp_eq_u64 vcc, exec
  s_cbranch_scc1 k1_cfT0
  s_cmp_gt_u32 s77, 200000
  s_cbranch_scc1 k1_cfT0
  buffer_load_dword v31, v46, s[20:23], 0 offen sc1
  s_waitcnt vmcnt(0)
  s_branch k1_cpT0
k1_cfT0:
  buffer_load_dwordx4 v[32:35], v16, s[20:23], s92 offen sc1
  buffer_load_dword v36, v47, s[20:23], s93 offen offset:0 sc1
  buffer_load_dword v37, v47, s[20:23], s93 offen offset:256 sc1
  buffer_load_dword v38, v47, s[20:23], s93 offen offset:512 sc1
  buffer_load_dword v39, v47, s[20:23], s93 offen offset:768 sc1
  v_mfma_f32_32x32x16_bf16 v[64:79], v[112:115], v[232:235], v[64:79]
  s_add_u32 m0, s69, 81920
  ds_read_b128 v[240:243], v8 offset:49152
  ds_read_b64_tr_b16 v[96:97], v12 offset:49152
  ds_read_b64_tr_b16 v[98:99], v12 offset:49664
  v_mfma_f32_32x32x16_bf16 v[80:95], v[116:119], v[232:235], v[80:95]
  ds_read_b64_tr_b16 v[100:101], v13 offset:49152
  ds_read_b64_tr_b16 v[102:103], v13 offset:49664
  buffer_load_dwordx4 v6, s[16:19], s68 offen lds
  s_waitcnt lgkmcnt(5)
  v_mfma_f32_32x32x16_bf16 v[64:79], v[120:123], v[236:239], v[64:79]
  ds_read_b128 v[244:247], v9 offset:49152
  ds_read_b64_tr_b16 v[104:105], v12 offset:51200
  ds_read_b64_tr_b16 v[106:107], v12 offset:51712
  v_mfma_f32_32x32x16_bf16 v[80:95], v[124:127], v[236:239], v[80:95]
  ds_read_b64_tr_b16 v[108:109], v13 offset:51200
  ds_read_b64_tr_b16 v[110:111], v13 offset:51712
  buffer_load_dwordx4 v7, s[16:19], s68 offen offset:1024 lds
  s_add_u32 s68, s68, 458752
  s_waitcnt lgkmcnt(5)
  v_mfma_f32_32x32x16_bf16 v[64:79], v[96:99], v[240:243], v[64:79]
  s_add_u32 m0, s69, 16384
  ds_read_b128 v[248:251], v10 offset:49152
  ds_read_b64_tr_b16 v[112:113], v12 offset:53248
  ds_read_b64_tr_b16 v[114:115], v12 offset:53760
  v_mfma_f32_32x32x16_bf16 v[80:95], v[100:103], v[240:243], v[80:95]
  ds_read_b64_tr_b16 v[116:117], v13 offset:53248
  ds_read_b64_tr_b16 v[118:119], v13 offset:53760
  buffer_load_dwordx4 v6, s[16:19], s70 offen lds
  s_waitcnt lgkmcnt(5)
  v_mfma_f32_32x32x16_bf16 v[64:79], v[104:107], v[244:247], v[64:79]
  ds_read_b128 v[252:255], v11 offset:49152
  ds_read_b64_tr_b16 v[120:121], v12 offset:55296
  ds_read_b64_tr_b16 v[122:123], v12 offset:55808
  v_mfma_f32_32x32x16_bf16 v[80:95], v[108:111], v[244:247], v[80:95]
  ds_read_b64_tr_b16 v[124:125], v13 offset:55296
  ds_read_b64_tr_b16 v[126:127], v13 offset:55808
  buffer_load_dwordx4 v7, s[16:19], s70 offen offset:1024 lds
  s_add_u32 s70, s70, 458752
  s_waitcnt lgkmcnt(5)
  s_barrier
  v_mfma_f32_32x32x16_bf16 v[64:79], v[112:115], v[248:251], v[64:79]
  s_add_u32 m0, s69, 98304
  v_mfma_f32_32x32x16_bf16 v[80:95], v[116:119], v[248:251], v[80:95]
  s_nop 0
  buffer_load_dwordx4 v6, s[16:19], s68 offen lds
  s_waitcnt lgkmcnt(0)
  v_mfma_f32_32x32x16_bf16 v[64:79], v[120:123], v[252:255], v[64:79]
  v_mfma_f32_32x32x16_bf16 v[80:95], v[124:127], v[252:255], v[80:95]
  buffer_load_dwordx4 v7, s[16:19], s68 offen offset:1024 lds
  s_add_u32 s68, s68, 458752
  s_add_u32 m0, s69, 32768
  s_nop 0
  buffer_load_dwordx4 v6, s[16:19], s70 offen lds
  buffer_load_dwordx4 v7, s[16:19], s70 offen offset:1024 lds
  s_add_u32 s70, s70, 458752
  s_waitcnt vmcnt(8)
  v_add_f32 v36, v36, v37
  v_add_f32 v38, v38, v39
  s_and_b32 s73, s56, 1
  s_lshl_b32 s73, s73, 8
  s_add_u32 s73, s73, 131072
  v_lshl_add_u32 v24, v0, 2, s73
  v_add_f32 v36, v36, v38
  ds_write_b32 v24, v32
  ds_write_b32 v24, v33 offset:512
  ds_write_b32 v24, v34 offset:1024
  s_lshl_b32 s73, s57, 8
  s_add_u32 s73, s73, 133120
  v_lshl_add_u32 v24, v0, 2, s73
  ds_write_b32 v24, v36
  v_and_b32 v24, 31, v0
  s_lshl_b32 s72, s57, 7
  s_add_u32 s72, s72, 131072
  v_lshl_add_u32 v23, v24, 2, s72
  s_waitcnt lgkmcnt(0)
  s_barrier
  s_add_u32 m0, s69, 114688
  s_nop 0
  buffer_load_dwordx4 v6, s[16:19], s68 offen lds
  buffer_load_dwordx4 v7, s[16:19], s68 offen offset:1024 lds
  s_add_u32 s68, s68, 458752
  s_add_u32 m0, s69, 49152
  s_nop 0
  buffer_load_dwordx4 v6, s[16:19], s70 offen lds
  buffer_load_dwordx4 v7, s[16:19], s70 offen offset:1024 lds
  s_add_u32 s70, s70, 458752
  ds_read_b32 v19, v23
  ds_read_b32 v18, v23 offset:512
  v_lshrrev_b32 v24, 5, v0
  v_lshlrev_b32 v24, 4, v24
  v_add_u32 v24, 133120, v24
  ds_read_b128 v[32:35], v24 offset:0
  ds_read_b128 v[36:39], v24 offset:32
  ds_read_b128 v[40:43], v24 offset:64
  ds_read_b128 v[44:47], v24 offset:96
  s_lshl_b32 s73, s60, 2
  s_add_u32 s73, s73, 0
  s_lshl_b32 s73, s73, 16
  s_lshl_b32 s74, s62, 10
  s_add_u32 s73, s73, s74
  s_add_u32 s73, s73, 0
  s_add_u32 s74, s73, 65536
  s_waitcnt lgkmcnt(0)
  v_mul_f32 v30, 0x3eb8aa3b, v19
  v_pk_fma_f32 v[64:65], v[32:33], v[18:19], v[64:65] op_sel_hi:[1,0,1]
  v_pk_fma_f32 v[66:67], v[34:35], v[18:19], v[66:67] op_sel_hi:[1,0,1]
  v_pk_fma_f32 v[68:69], v[36:37], v[18:19], v[68:69] op_sel_hi:[1,0,1]
  v_pk_fma_f32 v[70:71], v[38:39], v[18:19], v[70:71] op_sel_hi:[1,0,1]
  v_pk_fma_f32 v[72:73], v[40:41], v[18:19], v[72:73] op_sel_hi:[1,0,1]
  v_pk_fma_f32 v[74:75], v[42:43], v[18:19], v[74:75] op_sel_hi:[1,0,1]
  v_pk_fma_f32 v[76:77], v[44:45], v[18:19], v[76:77] op_sel_hi:[1,0,1]
  v_pk_fma_f32 v[78:79], v[46:47], v[18:19], v[78:79] op_sel_hi:[1,0,1]
  v_pk_mul_f32 v[64:65], v[64:65], v[30:31] op_sel_hi:[1,0]
  v_pk_mul_f32 v[66:67], v[66:67], v[30:31] op_sel_hi:[1,0]
  v_pk_mul_f32 v[68:69], v[68:69], v[30:31] op_sel_hi:[1,0]
  v_pk_mul_f32 v[70:71], v[70:71], v[30:31] op_sel_hi:[1,0]
  v_pk_mul_f32 v[72:73], v[72:73], v[30:31] op_sel_hi:[1,0]
  v_pk_mul_f32 v[74:75], v[74:75], v[30:31] op_sel_hi:[1,0]
  v_pk_mul_f32 v[76:77], v[76:77], v[30:31] op_sel_hi:[1,0]
  v_pk_mul_f32 v[78:79], v[78:79], v[30:31] op_sel_hi:[1,0]
  v_pk_mul_f32 v[24:25], v[64:65], v[64:65]
  v_pk_fma_f32 v[24:25], v[66:67], v[66:67], v[24:25]
  v_pk_fma_f32 v[24:25], v[68:69], v[68:69], v[24:25]
  v_pk_fma_f32 v[24:25], v[70:71], v[70:71], v[24:25]
  v_pk_mul_f32 v[26:27], v[72:73], v[72:73]
  v_pk_fma_f32 v[26:27], v[74:75], v[74:75], v[26:27]
  v_pk_fma_f32 v[26:27], v[76:77], v[76:77], v[26:27]
  v_pk_fma_f32 v[26:27], v[78:79], v[78:79], v[26:27]
  v_add_f32 v24, v24, v25
  v_add_f32 v26, v26, v27
  v_max3_f32 v22, v24, v26, v22
  v_cvt_pk_bf16_f32 v64, v64, v65
  v_cvt_pk_bf16_f32 v65, v66, v67
  v_cvt_pk_bf16_f32 v66, v68, v69
  v_cvt_pk_bf16_f32 v67, v70, v71
  v_cvt_pk_bf16_f32 v68, v72, v73
  v_cvt_pk_bf16_f32 v69, v74, v75
  v_cvt_pk_bf16_f32 v70, v76, v77
  v_cvt_pk_bf16_f32 v71, v78, v79
  buffer_store_dwordx4 v[64:67], v16, s[20:23], s73 offen sc1
  buffer_store_dwordx4 v[68:71], v16, s[20:23], s74 offen sc1
  v_lshrrev_b32 v24, 5, v0
  v_lshlrev_b32 v24, 4, v24
  v_add_u32 v24, 133248, v24
  ds_read_b128 v[32:35], v24 offset:0
  ds_read_b128 v[36:39], v24 offset:32
  ds_read_b128 v[40:43], v24 offset:64
  ds_read_b128 v[44:47], v24 offset:96
  s_lshl_b32 s73, s60, 2
  s_add_u32 s73, s73, 2
  s_lshl_b32 s73, s73, 16
  s_lshl_b32 s74, s62, 10
  s_add_u32 s73, s73, s74
  s_add_u32 s73, s73, 0
  s_add_u32 s74, s73, 65536
  s_waitcnt lgkmcnt(0)
  v_mul_f32 v30, 0x3eb8aa3b, v19
  v_pk_fma_f32 v[80:81], v[32:33], v[18:19], v[80:81] op_sel_hi:[1,0,1]
  v_pk_fma_f32 v[82:83], v[34:35], v[18:19], v[82:83] op_sel_hi:[1,0,1]
  v_pk_fma_f32 v[84:85], v[36:37], v[18:19], v[84:85] op_sel_hi:[1,0,1]
  v_pk_fma_f32 v[86:87], v[38:39], v[18:19], v[86:87] op_sel_hi:[1,0,1]
  v_pk_fma_f32 v[88:89], v[40:41], v[18:19], v[88:89] op_sel_hi:[1,0,1]
  v_pk_fma_f32 v[90:91], v[42:43], v[18:19], v[90:91] op_sel_hi:[1,0,1]
  v_pk_fma_f32 v[92:93], v[44:45], v[18:19], v[92:93] op_sel_hi:[1,0,1]
  v_pk_fma_f32 v[94:95], v[46:47], v[18:19], v[94:95] op_sel_hi:[1,0,1]
  v_pk_mul_f32 v[80:81], v[80:81], v[30:31] op_sel_hi:[1,0]
  v_pk_mul_f32 v[82:83], v[82:83], v[30:31] op_sel_hi:[1,0]
  v_pk_mul_f32 v[84:85], v[84:85], v[30:31] op_sel_hi:[1,0]
  v_pk_mul_f32 v[86:87], v[86:87], v[30:31] op_sel_hi:[1,0]
  v_pk_mul_f32 v[88:89], v[88:89], v[30:31] op_sel_hi:[1,0]
  v_pk_mul_f32 v[90:91], v[90:91], v[30:31] op_sel_hi:[1,0]
  v_pk_mul_f32 v[92:93], v[92:93], v[30:31] op_sel_hi:[1,0]
  v_pk_mul_f32 v[94:95], v[94:95], v[30:31] op_sel_hi:[1,0]
  v_pk_mul_f32 v[24:25], v[80:81], v[80:81]
  v_pk_fma_f32 v[24:25], v[82:83], v[82:83], v[24:25]
  v_pk_fma_f32 v[24:25], v[84:85], v[84:85], v[24:25]
  v_pk_fma_f32 v[24:25], v[86:87], v[86:87], v[24:25]
  v_pk_mul_f32 v[26:27], v[88:89], v[88:89]
  v_pk_fma_f32 v[26:27], v[90:91], v[90:91], v[26:27]
  v_pk_fma_f32 v[26:27], v[92:93], v[92:93], v[26:27]
  v_pk_fma_f32 v[26:27], v[94:95], v[94:95], v[26:27]
  v_add_f32 v24, v24, v25
  v_add_f32 v26, v26, v27
  v_max3_f32 v22, v24, v26, v22
  v_cvt_pk_bf16_f32 v80, v80, v81
  v_cvt_pk_bf16_f32 v81, v82, v83
  v_cvt_pk_bf16_f32 v82, v84, v85
  v_cvt_pk_bf16_f32 v83, v86, v87
  v_cvt_pk_bf16_f32 v84, v88, v89
  v_cvt_pk_bf16_f32 v85, v90, v91
  v_cvt_pk_bf16_f32 v86, v92, v93
  v_cvt_pk_bf16_f32 v87, v94, v95
  buffer_store_dwordx4 v[80:83], v16, s[20:23], s73 offen sc1
  buffer_store_dwordx4 v[84:87], v16, s[20:23], s74 offen sc1
  s_nop 1
  v_max_f32_dpp v22, v22, v22 row_ror:8 row_mask:0xf bank_mask:0xf
  s_nop 1
  v_max_f32_dpp v22, v22, v22 row_ror:4 row_mask:0xf bank_mask:0xf
  s_nop 1
  v_max_f32_dpp v22, v22, v22 row_ror:2 row_mask:0xf bank_mask:0xf
  s_nop 1
  v_max_f32_dpp v22, v22, v22 row_ror:1 row_mask:0xf bank_mask:0xf
  v_mov_b32 v24, v22
  s_nop 1
  v_permlane16_swap_b32 v22, v24
  s_nop 1
  v_max_f32 v22, v22, v24
  v_mov_b32 v24, v22
  s_nop 1
  v_permlane32_swap_b32 v22, v24
  s_nop 1
  v_max_f32 v22, v22, v24
  s_lshl_b32 s73, s60, 6
  s_add_u32 s73, s73, s62
  s_lshl_b32 s73, s73, 2
  s_add_u32 s73, s73, 6291456
  v_mov_b32 v24, 0
  buffer_store_dword v22, v24, s[20:23], s73 offen sc1
  s_waitcnt vmcnt(5)
  s_barrier
  s_and_b32 s77, s60, 1
  s_lshl_b32 s77, s77, 6
  v_subrev_u32 v17, 65536, v14
  v_xor_b32 v17, s77, v17
  s_add_u32 s83, s81, 0
  s_lshr_b32 s83, s83, 1
  ds_read_b64_tr_b16 v[96:97], v14 offset:0
  ds_read_b64_tr_b16 v[98:99], v14 offset:512
  ds_read_b64_tr_b16 v[100:101], v14 offset:2048
  ds_read_b64_tr_b16 v[102:103], v14 offset:2560
  ds_read_b64_tr_b16 v[104:105], v14 offset:4096
  ds_read_b64_tr_b16 v[106:107], v14 offset:4608
  s_waitcnt lgkmcnt(4)
  v_mfma_f32_32x32x16_bf16 v[64:79], v[96:99], v[128:131], 0
  ds_read_b64_tr_b16 v[108:109], v14 offset:6144
  ds_read_b64_tr_b16 v[110:111], v14 offset:6656
  s_waitcnt lgkmcnt(4)
  v_mfma_f32_32x32x16_bf16 v[64:79], v[100:103], v[132:135], v[64:79]
  ds_read_b64_tr_b16 v[96:97], v14 offset:8192
  ds_read_b64_tr_b16 v[98:99], v14 offset:8704
  s_waitcnt lgkmcnt(4)
  v_mfma_f32_32x32x16_bf16 v[64:79], v[104:107], v[136:139], v[64:79]
  ds_read_b64_tr_b16 v[100:101], v14 offset:10240
  ds_read_b64_tr_b16 v[102:103], v14 offset:10752
  s_waitcnt lgkmcnt(4)
  v_mfma_f32_32x32x16_bf16 v[64:79], v[108:111], v[140:143], v[64:79]
  ds_read_b64_tr_b16 v[104:105], v14 offset:12288
  ds_read_b64_tr_b16 v[106:107], v14 offset:12800
  s_waitcnt lgkmcnt(4)
  v_mfma_f32_32x32x16_bf16 v[64:79], v[96:99], v[144:147], v[64:79]
  ds_read_b64_tr_b16 v[108:109], v14 offset:14336
  ds_read_b64_tr_b16 v[110:111], v14 offset:14848
  s_waitcnt lgkmcnt(4)
  v_mfma_f32_32x32x16_bf16 v[64:79], v[100:103], v[148:151], v[64:79]
  ds_read_b64_tr_b16 v[96:97], v14 offset:16384
  ds_read_b64_tr_b16 v[98:99], v14 offset:16896
  s_waitcnt lgkmcnt(4)
  v_mfma_f32_32x32x16_bf16 v[64:79], v[104:107], v[152:155], v[64:79]
  ds_read_b64_tr_b16 v[100:101], v14 offset:18432
  ds_read_b64_tr_b16 v[102:103], v14 offset:18944
  s_waitcnt lgkmcnt(4)
  v_mfma_f32_32x32x16_bf16 v[64:79], v[108:111], v[156:159], v[64:79]
  ds_read_b64_tr_b16 v[104:105], v14 offset:20480
  ds_read_b64_tr_b16 v[106:107], v14 offset:20992
  s_waitcnt lgkmcnt(4)
  v_mfma_f32_32x32x16_bf16 v[64:79], v[96:99], v[160:163], v[64:79]
  ds_read_b64_tr_b16 v[108:109], v14 offset:22528
  ds_read_b64_tr_b16 v[110:111], v14 offset:23040
  s_waitcnt lgkmcnt(4)
  v_mfma_f32_32x32x16_bf16 v[64:79], v[100:103], v[164:167], v[64:79]
  ds_read_b64_tr_b16 v[96:97], v14 offset:24576
  ds_read_b64_tr_b16 v[98:99], v14 offset:25088
  s_waitcnt lgkmcnt(4)
  v_mfma_f32_32x32x16_bf16 v[64:79], v[104:107], v[168:171], v[64:79]
  ds_read_b64_tr_b16 v[100:101], v14 offset:26624
  ds_read_b64_tr_b16 v[102:103], v14 offset:27136
  s_waitcnt lgkmcnt(4)
  v_mfma_f32_32x32x16_bf16 v[64:79], v[108:111], v[172:175], v[64:79]
  ds_read_b64_tr_b16 v[104:105], v14 offset:28672
  ds_read_b64_tr_b16 v[106:107], v14 offset:29184
  s_waitcnt lgkmcnt(4)
  v_mfma_f32_32x32x16_bf16 v[64:79], v[96:99], v[176:179], v[64:79]
  ds_read_b64_tr_b16 v[108:109], v14 offset:30720
  ds_read_b64_tr_b16 v[110:111], v14 offset:31232
  s_waitcnt lgkmcnt(4)
  v_mfma_f32_32x32x16_bf16 v[64:79], v[100:103], v[180:183], v[64:79]
  ds_read_b64_tr_b16 v[96:97], v14 offset:32768
  ds_read_b64_tr_b16 v[98:99], v14 offset:33280
  s_waitcnt lgkmcnt(4)
  v_mfma_f32_32x32x16_bf16 v[64:79], v[104:107], v[184:187], v[64:79]
  ds_read_b64_tr_b16 v[100:101], v14 offset:34816
  ds_read_b64_tr_b16 v[102:103], v14 offset:35328
  s_waitcnt lgkmcnt(4)
  v_mfma_f32_32x32x16_bf16 v[64:79], v[108:111], v[188:191], v[64:79]
  ds_read_b64_tr_b16 v[104:105], v14 offset:36864
  ds_read_b64_tr_b16 v[106:107], v14 offset:37376
  s_waitcnt lgkmcnt(4)
  v_mfma_f32_32x32x16_bf16 v[64:79], v[96:99], v[192:195], v[64:79]
  ds_read_b64_tr_b16 v[108:109], v14 offset:38912
  ds_read_b64_tr_b16 v[110:111], v14 offset:39424
  s_waitcnt lgkmcnt(4)
  v_mfma_f32_32x32x16_bf16 v[64:79], v[100:103], v[196:199], v[64:79]
  ds_read_b64_tr_b16 v[96:97], v14 offset:40960
  ds_read_b64_tr_b16 v[98:99], v14 offset:41472
  s_waitcnt lgkmcnt(4)
  v_mfma_f32_32x32x16_bf16 v[64:79], v[104:107], v[200:203], v[64:79]
  ds_read_b64_tr_b16 v[100:101], v14 offset:43008
  ds_read_b64_tr_b16 v[102:103], v14 offset:43520
  s_waitcnt lgkmcnt(4)
  v_mfma_f32_32x32x16_bf16 v[64:79], v[108:111], v[204:207], v[64:79]
  ds_read_b64_tr_b16 v[104:105], v14 offset:45056
  ds_read_b64_tr_b16 v[106:107], v14 offset:45568
  s_waitcnt lgkmcnt(4)
  v_mfma_f32_32x32x16_bf16 v[64:79], v[96:99], v[208:211], v[64:79]
  ds_read_b64_tr_b16 v[108:109], v14 offset:47104
  ds_read_b64_tr_b16 v[110:111], v14 offset:47616
  s_waitcnt lgkmcnt(4)
  v_mfma_f32_32x32x16_bf16 v[64:79], v[100:103], v[212:215], v[64:79]
  ds_read_b64_tr_b16 v[96:97], v14 offset:49152
  ds_read_b64_tr_b16 v[98:99], v14 offset:49664
  s_waitcnt lgkmcnt(4)
  v_mfma_f32_32x32x16_bf16 v[64:79], v[104:107], v[216:219], v[64:79]
  ds_read_b64_tr_b16 v[100:101], v14 offset:51200
  ds_read_b64_tr_b16 v[102:103], v14 offset:51712
  s_waitcnt lgkmcnt(4)
  v_mfma_f32_32x32x16_bf16 v[64:79], v[108:111], v[220:223], v[64:79]
  ds_read_b64_tr_b16 v[104:105], v14 offset:53248
  ds_read_b64_tr_b16 v[106:107], v14 offset:53760
  s_waitcnt lgkmcnt(4)
  v_mfma_f32_32x32x16_bf16 v[64:79], v[96:99], v[224:227], v[64:79]
  ds_read_b64_tr_b16 v[108:109], v14 offset:55296
  ds_read_b64_tr_b16 v[110:111], v14 offset:55808
  s_waitcnt lgkmcnt(4)
  v_mfma_f32_32x32x16_bf16 v[64:79], v[100:103], v[228:231], v[64:79]
  ds_read_b64_tr_b16 v[96:97], v14 offset:57344
  ds_read_b64_tr_b16 v[98:99], v14 offset:57856
  s_waitcnt lgkmcnt(4)
  v_mfma_f32_32x32x16_bf16 v[64:79], v[104:107], v[232:235], v[64:79]
  ds_read_b64_tr_b16 v[100:101], v14 offset:59392
  ds_read_b64_tr_b16 v[102:103], v14 offset:59904
  s_waitcnt lgkmcnt(4)
  v_mfma_f32_32x32x16_bf16 v[64:79], v[108:111], v[236:239], v[64:79]
  ds_read_b64_tr_b16 v[104:105], v14 offset:61440
  ds_read_b64_tr_b16 v[106:107], v14 offset:61952
  s_waitcnt lgkmcnt(4)
  v_mfma_f32_32x32x16_bf16 v[64:79], v[96:99], v[240:243], v[64:79]
  ds_read_b64_tr_b16 v[108:109], v14 offset:63488
  ds_read_b64_tr_b16 v[110:111], v14 offset:64000
  s_waitcnt lgkmcnt(4)
  v_mfma_f32_32x32x16_bf16 v[64:79], v[100:103], v[244:247], v[64:79]
  s_waitcnt lgkmcnt(2)
  v_mfma_f32_32x32x16_bf16 v[64:79], v[104:107], v[248:251], v[64:79]
  s_waitcnt lgkmcnt(0)
  v_mfma_f32_32x32x16_bf16 v[64:79], v[108:111], v[252:255], v[64:79]
  s_waitcnt vmcnt(0)
  v_mov_b32 v24, 137216
  v_mov_b32 v25, 1
  s_mov_b64 exec, 1
  ds_add_rtn_u32 v26, v24, v25
  s_mov_b64 exec, -1
  s_lshl_b32 s73, s60, 5
  s_lshl_b32 s74, s61, 4
  s_add_u32 s73, s73, s74
  s_add_u32 s73, s73, s59
  s_lshl_b32 s73, s73, 2
  s_add_u32 s73, s73, 20975616
  s_waitcnt lgkmcnt(0)
  v_readfirstlane_b32 s74, v26
  s_cmp_eq_u32 s74, 7
  s_cbranch_scc0 k1_p1xa
  v_mov_b32 v24, s90
  v_mov_b32 v25, 0
  s_mov_b64 exec, 1
  buffer_store_dword v24, v25, s[20:23], s73 offen sc1
  s_mov_b64 exec, -1
k1_p1xa:
  v_lshrrev_b32 v24, 5, v0
  v_lshlrev_b32 v24, 4, v24
  v_add_u32 v24, 133632, v24
  ds_read_b128 v[32:35], v24 offset:0
  ds_read_b128 v[36:39], v24 offset:32
  ds_read_b128 v[40:43], v24 offset:64
  ds_read_b128 v[44:47], v24 offset:96
  v_lshrrev_b32 v25, 5, v0
  v_lshlrev_b32 v25, 4, v25
  v_add_u32 v25, 134656, v25
  ds_read_b128 v[48:51], v25 offset:0
  ds_read_b128 v[52:55], v25 offset:32
  ds_read_b128 v[56:59], v25 offset:64
  ds_read_b128 v[60:63], v25 offset:96
  s_mul_i32 s73, s62, 144
  s_lshr_b32 s74, s83, 4
  s_add_u32 s73, s73, s74
  s_lshl_b32 s73, s73, 10
  s_add_u32 s73, s73, 10485760
  s_waitcnt lgkmcnt(0)
  v_fma_f32 v64, v32, v18, v64
  v_fma_f32 v65, v33, v18, v65
  v_fma_f32 v66, v34, v18, v66
  v_fma_f32 v67, v35, v18, v67
  v_fma_f32 v68, v36, v18, v68
  v_fma_f32 v69, v37, v18, v69
  v_fma_f32 v70, v38, v18, v70
  v_fma_f32 v71, v39, v18, v71
  v_fma_f32 v72, v40, v18, v72
  v_fma_f32 v73, v41, v18, v73
  v_fma_f32 v74, v42, v18, v74
  v_fma_f32 v75, v43, v18, v75
  v_fma_f32 v76, v44, v18, v76
  v_fma_f32 v77, v45, v18, v77
  v_fma_f32 v78, v46, v18, v78
  v_fma_f32 v79, v47, v18, v79
  v_fma_f32 v64, v64, v19, v48
  v_fma_f32 v65, v65, v19, v49
  v_fma_f32 v66, v66, v19, v50
  v_fma_f32 v67, v67, v19, v51
  v_fma_f32 v68, v68, v19, v52
  v_fma_f32 v69, v69, v19, v53
  v_fma_f32 v70, v70, v19, v54
  v_fma_f32 v71, v71, v19, v55
  v_fma_f32 v72, v72, v19, v56
  v_fma_f32 v73, v73, v19, v57
  v_fma_f32 v74, v74, v19, v58
  v_fma_f32 v75, v75, v19, v59
  v_fma_f32 v76, v76, v19, v60
  v_fma_f32 v77, v77, v19, v61
  v_fma_f32 v78, v78, v19, v62
  v_fma_f32 v79, v79, v19, v63
  v_mul_f32 v32, 0x3fb8aa3b, v64
  v_mul_f32 v33, 0x3fb8aa3b, v65
  v_mul_f32 v34, 0x3fb8aa3b, v66
  v_mul_f32 v35, 0x3fb8aa3b, v67
  v_mul_f32 v36, 0x3fb8aa3b, v68
  v_mul_f32 v37, 0x3fb8aa3b, v69
  v_mul_f32 v38, 0x3fb8aa3b, v70
  v_mul_f32 v39, 0x3fb8aa3b, v71
  v_mul_f32 v40, 0x3fb8aa3b, v72
  v_mul_f32 v41, 0x3fb8aa3b, v73
  v_mul_f32 v42, 0x3fb8aa3b, v74
  v_mul_f32 v43, 0x3fb8aa3b, v75
  v_mul_f32 v44, 0x3fb8aa3b, v76
  v_mul_f32 v45, 0x3fb8aa3b, v77
  v_mul_f32 v46, 0x3fb8aa3b, v78
  v_mul_f32 v47, 0x3fb8aa3b, v79
  v_exp_f32 v32, v32
  v_exp_f32 v33, v33
  v_exp_f32 v34, v34
  v_exp_f32 v35, v35
  v_exp_f32 v36, v36
  v_exp_f32 v37, v37
  v_exp_f32 v38, v38
  v_exp_f32 v39, v39
  v_exp_f32 v40, v40
  v_exp_f32 v41, v41
  v_exp_f32 v42, v42
  v_exp_f32 v43, v43
  v_exp_f32 v44, v44
  v_exp_f32 v45, v45
  v_exp_f32 v46, v46
  v_exp_f32 v47, v47
  v_fma_f32 v48, 0.5, v32, 1.0
  v_fma_f32 v49, 0.5, v33, 1.0
  v_fma_f32 v50, 0.5, v34, 1.0
  v_fma_f32 v51, 0.5, v35, 1.0
  v_fma_f32 v52, 0.5, v36, 1.0
  v_fma_f32 v53, 0.5, v37, 1.0
  v_fma_f32 v54, 0.5, v38, 1.0
  v_fma_f32 v55, 0.5, v39, 1.0
  v_fma_f32 v56, 0.5, v40, 1.0
  v_fma_f32 v57, 0.5, v41, 1.0
  v_fma_f32 v58, 0.5, v42, 1.0
  v_fma_f32 v59, 0.5, v43, 1.0
  v_fma_f32 v60, 0.5, v44, 1.0
  v_fma_f32 v61, 0.5, v45, 1.0
  v_fma_f32 v62, 0.5, v46, 1.0
  v_fma_f32 v63, 0.5, v47, 1.0
  v_fma_f32 v48, v48, v32, 1.0
  v_fma_f32 v49, v49, v33, 1.0
  v_fma_f32 v50, v50, v34, 1.0
  v_fma_f32 v51, v51, v35, 1.0
  v_fma_f32 v52, v52, v36, 1.0
  v_fma_f32 v53, v53, v37, 1.0
  v_fma_f32 v54, v54, v38, 1.0
  v_fma_f32 v55, v55, v39, 1.0
  v_fma_f32 v56, v56, v40, 1.0
  v_fma_f32 v57, v57, v41, 1.0
  v_fma_f32 v58, v58, v42, 1.0
  v_fma_f32 v59, v59, v43, 1.0
  v_fma_f32 v60, v60, v44, 1.0
  v_fma_f32 v61, v61, v45, 1.0
  v_fma_f32 v62, v62, v46, 1.0
  v_fma_f32 v63, v63, v47, 1.0
  v_rcp_f32 v48, v48
  v_rcp_f32 v49, v49
  v_rcp_f32 v50, v50
  v_rcp_f32 v51, v51
  v_rcp_f32 v52, v52
  v_rcp_f32 v53, v53
  v_rcp_f32 v54, v54
  v_rcp_f32 v55, v55
  v_rcp_f32 v56, v56
  v_rcp_f32 v57, v57
  v_rcp_f32 v58, v58
  v_rcp_f32 v59, v59
  v_rcp_f32 v60, v60
  v_rcp_f32 v61, v61
  v_rcp_f32 v62, v62
  v_rcp_f32 v63, v63
  s_nop 0
  v_fma_f32 v64, -v64, v48, v64
  v_fma_f32 v65, -v65, v49, v65
  v_fma_f32 v66, -v66, v50, v66
  v_fma_f32 v67, -v67, v51, v67
  v_fma_f32 v68, -v68, v52, v68
  v_fma_f32 v69, -v69, v53, v69
  v_fma_f32 v70, -v70, v54, v70
  v_fma_f32 v71, -v71, v55, v71
  v_fma_f32 v72, -v72, v56, v72
  v_fma_f32 v73, -v73, v57, v73
  v_fma_f32 v74, -v74, v58, v74
  v_fma_f32 v75, -v75, v59, v75
  v_fma_f32 v76, -v76, v60, v76
  v_fma_f32 v77, -v77, v61, v77
  v_fma_f32 v78, -v78, v62, v78
  v_fma_f32 v79, -v79, v63, v79
  v_cvt_pk_bf16_f32 v64, v64, v65
  v_cvt_pk_bf16_f32 v65, v66, v67
  v_cvt_pk_bf16_f32 v66, v68, v69
  v_cvt_pk_bf16_f32 v67, v70, v71
  v_cvt_pk_bf16_f32 v68, v72, v73
  v_cvt_pk_bf16_f32 v69, v74, v75
  v_cvt_pk_bf16_f32 v70, v76, v77
  v_cvt_pk_bf16_f32 v71, v78, v79
  buffer_store_dwordx4 v[64:67], v16, s[20:23], s73 offen sc1
  buffer_store_dwordx4 v[68:71], v16, s[20:23], s73 offen offset:1024 sc1
  s_and_b32 s77, s60, 1
  s_lshl_b32 s77, s77, 6
  s_add_u32 s83, s82, s77
  s_lshr_b32 s83, s83, 1
  ds_read_b64_tr_b16 v[96:97], v17 offset:0
  ds_read_b64_tr_b16 v[98:99], v17 offset:512
  ds_read_b64_tr_b16 v[100:101], v17 offset:2048
  ds_read_b64_tr_b16 v[102:103], v17 offset:2560
  ds_read_b64_tr_b16 v[104:105], v17 offset:4096
  ds_read_b64_tr_b16 v[106:107], v17 offset:4608
  s_waitcnt lgkmcnt(4)
  v_mfma_f32_32x32x16_bf16 v[64:79], v[96:99], v[128:131], 0
  ds_read_b64_tr_b16 v[108:109], v17 offset:6144
  ds_read_b64_tr_b16 v[110:111], v17 offset:6656
  s_waitcnt lgkmcnt(4)
  v_mfma_f32_32x32x16_bf16 v[64:79], v[100:103], v[132:135], v[64:79]
  ds_read_b64_tr_b16 v[96:97], v17 offset:8192
  ds_read_b64_tr_b16 v[98:99], v17 offset:8704
  s_waitcnt lgkmcnt(4)
  v_mfma_f32_32x32x16_bf16 v[64:79], v[104:107], v[136:139], v[64:79]
  ds_read_b64_tr_b16 v[100:101], v17 offset:10240
  ds_read_b64_tr_b16 v[102:103], v17 offset:10752
  s_waitcnt lgkmcnt(4)
  v_mfma_f32_32x32x16_bf16 v[64:79], v[108:111], v[140:143], v[64:79]
  ds_read_b64_tr_b16 v[104:105], v17 offset:12288
  ds_read_b64_tr_b16 v[106:107], v17 offset:12800
  s_waitcnt lgkmcnt(4)
  v_mfma_f32_32x32x16_bf16 v[64:79], v[96:99], v[144:147], v[64:79]
  ds_read_b64_tr_b16 v[108:109], v17 offset:14336
  ds_read_b64_tr_b16 v[110:111], v17 offset:14848
  s_waitcnt lgkmcnt(4)
  v_mfma_f32_32x32x16_bf16 v[64:79], v[100:103], v[148:151], v[64:79]
  ds_read_b64_tr_b16 v[96:97], v17 offset:16384
  ds_read_b64_tr_b16 v[98:99], v17 offset:16896
  s_waitcnt lgkmcnt(4)
  v_mfma_f32_32x32x16_bf16 v[64:79], v[104:107], v[152:155], v[64:79]
  ds_read_b64_tr_b16 v[100:101], v17 offset:18432
  ds_read_b64_tr_b16 v[102:103], v17 offset:18944
  s_waitcnt lgkmcnt(4)
  v_mfma_f32_32x32x16_bf16 v[64:79], v[108:111], v[156:159], v[64:79]
  ds_read_b64_tr_b16 v[104:105], v17 offset:20480
  ds_read_b64_tr_b16 v[106:107], v17 offset:20992
  s_waitcnt lgkmcnt(4)
  v_mfma_f32_32x32x16_bf16 v[64:79], v[96:99], v[160:163], v[64:79]
  ds_read_b64_tr_b16 v[108:109], v17 offset:22528
  ds_read_b64_tr_b16 v[110:111], v17 offset:23040
  s_waitcnt lgkmcnt(4)
  v_mfma_f32_32x32x16_bf16 v[64:79], v[100:103], v[164:167], v[64:79]
  ds_read_b64_tr_b16 v[96:97], v17 offset:24576
  ds_read_b64_tr_b16 v[98:99], v17 offset:25088
  s_waitcnt lgkmcnt(4)
  v_mfma_f32_32x32x16_bf16 v[64:79], v[104:107], v[168:171], v[64:79]
  ds_read_b64_tr_b16 v[100:101], v17 offset:26624
  ds_read_b64_tr_b16 v[102:103], v17 offset:27136
  s_waitcnt lgkmcnt(4)
  v_mfma_f32_32x32x16_bf16 v[64:79], v[108:111], v[172:175], v[64:79]
  ds_read_b64_tr_b16 v[104:105], v17 offset:28672
  ds_read_b64_tr_b16 v[106:107], v17 offset:29184
  s_waitcnt lgkmcnt(4)
  v_mfma_f32_32x32x16_bf16 v[64:79], v[96:99], v[176:179], v[64:79]
  ds_read_b64_tr_b16 v[108:109], v17 offset:30720
  ds_read_b64_tr_b16 v[110:111], v17 offset:31232
  s_waitcnt lgkmcnt(4)
  v_mfma_f32_32x32x16_bf16 v[64:79], v[100:103], v[180:183], v[64:79]
  ds_read_b64_tr_b16 v[96:97], v17 offset:32768
  ds_read_b64_tr_b16 v[98:99], v17 offset:33280
  s_waitcnt lgkmcnt(4)
  v_mfma_f32_32x32x16_bf16 v[64:79], v[104:107], v[184:187], v[64:79]
  ds_read_b64_tr_b16 v[100:101], v17 offset:34816
  ds_read_b64_tr_b16 v[102:103], v17 offset:35328
  s_waitcnt lgkmcnt(4)
  v_mfma_f32_32x32x16_bf16 v[64:79], v[108:111], v[188:191], v[64:79]
  ds_read_b64_tr_b16 v[104:105], v17 offset:36864
  ds_read_b64_tr_b16 v[106:107], v17 offset:37376
  s_waitcnt lgkmcnt(4)
  v_mfma_f32_32x32x16_bf16 v[64:79], v[96:99], v[192:195], v[64:79]
  ds_read_b64_tr_b16 v[108:109], v17 offset:38912
  ds_read_b64_tr_b16 v[110:111], v17 offset:39424
  s_waitcnt lgkmcnt(4)
  v_mfma_f32_32x32x16_bf16 v[64:79], v[100:103], v[196:199], v[64:79]
  ds_read_b64_tr_b16 v[96:97], v17 offset:40960
  ds_read_b64_tr_b16 v[98:99], v17 offset:41472
  s_waitcnt lgkmcnt(4)
  v_mfma_f32_32x32x16_bf16 v[64:79], v[104:107], v[200:203], v[64:79]
  ds_read_b64_tr_b16 v[100:101], v17 offset:43008
  ds_read_b64_tr_b16 v[102:103], v17 offset:43520
  s_waitcnt lgkmcnt(4)
  v_mfma_f32_32x32x16_bf16 v[64:79], v[108:111], v[204:207], v[64:79]
  ds_read_b64_tr_b16 v[104:105], v17 offset:45056
  ds_read_b64_tr_b16 v[106:107], v17 offset:45568
  s_waitcnt lgkmcnt(4)
  v_mfma_f32_32x32x16_bf16 v[64:79], v[96:99], v[208:211], v[64:79]
  ds_read_b64_tr_b16 v[108:109], v17 offset:47104
  ds_read_b64_tr_b16 v[110:111], v17 offset:47616
  s_waitcnt lgkmcnt(4)
  v_mfma_f32_32x32x16_bf16 v[64:79], v[100:103], v[212:215], v[64:79]
  ds_read_b64_tr_b16 v[96:97], v17 offset:49152
  ds_read_b64_tr_b16 v[98:99], v17 offset:49664
  s_waitcnt lgkmcnt(4)
  v_mfma_f32_32x32x16_bf16 v[64:79], v[104:107], v[216:219], v[64:79]
  ds_read_b64_tr_b16 v[100:101], v17 offset:51200
  ds_read_b64_tr_b16 v[102:103], v17 offset:51712
  s_waitcnt lgkmcnt(4)
  v_mfma_f32_32x32x16_bf16 v[64:79], v[108:111], v[220:223], v[64:79]
  ds_read_b64_tr_b16 v[104:105], v17 offset:53248
  ds_read_b64_tr_b16 v[106:107], v17 offset:53760
  s_waitcnt lgkmcnt(4)
  v_mfma_f32_32x32x16_bf16 v[64:79], v[96:99], v[224:227], v[64:79]
  ds_read_b64_tr_b16 v[108:109], v17 offset:55296
  ds_read_b64_tr_b16 v[110:111], v17 offset:55808
  s_waitcnt lgkmcnt(4)
  v_mfma_f32_32x32x16_bf16 v[64:79], v[100:103], v[228:231], v[64:79]
  ds_read_b64_tr_b16 v[96:97], v17 offset:57344
  ds_read_b64_tr_b16 v[98:99], v17 offset:57856
  s_waitcnt lgkmcnt(4)
  v_mfma_f32_32x32x16_bf16 v[64:79], v[104:107], v[232:235], v[64:79]
  ds_read_b64_tr_b16 v[100:101], v17 offset:59392
  ds_read_b64_tr_b16 v[102:103], v17 offset:59904
  s_waitcnt lgkmcnt(4)
  v_mfma_f32_32x32x16_bf16 v[64:79], v[108:111], v[236:239], v[64:79]
  ds_read_b64_tr_b16 v[104:105], v17 offset:61440
  ds_read_b64_tr_b16 v[106:107], v17 offset:61952
  s_waitcnt lgkmcnt(4)
  v_mfma_f32_32x32x16_bf16 v[64:79], v[96:99], v[240:243], v[64:79]
  ds_read_b64_tr_b16 v[108:109], v17 offset:63488
  ds_read_b64_tr_b16 v[110:111], v17 offset:64000
  s_waitcnt lgkmcnt(4)
  v_mfma_f32_32x32x16_bf16 v[64:79], v[100:103], v[244:247], v[64:79]
  s_waitcnt lgkmcnt(2)
  v_mfma_f32_32x32x16_bf16 v[64:79], v[104:107], v[248:251], v[64:79]
  s_waitcnt lgkmcnt(0)
  v_mfma_f32_32x32x16_bf16 v[64:79], v[108:111], v[252:255], v[64:79]
  v_lshrrev_b32 v24, 5, v0
  v_lshlrev_b32 v24, 4, v24
  v_add_u32 v24, 133888, v24
  ds_read_b128 v[32:35], v24 offset:0
  ds_read_b128 v[36:39], v24 offset:32
  ds_read_b128 v[40:43], v24 offset:64
  ds_read_b128 v[44:47], v24 offset:96
  v_lshrrev_b32 v25, 5, v0
  v_lshlrev_b32 v25, 4, v25
  v_add_u32 v25, 134912, v25
  ds_read_b128 v[48:51], v25 offset:0
  ds_read_b128 v[52:55], v25 offset:32
  ds_read_b128 v[56:59], v25 offset:64
  ds_read_b128 v[60:63], v25 offset:96
  s_mul_i32 s73, s62, 144
  s_lshr_b32 s74, s83, 4
  s_add_u32 s73, s73, s74
  s_lshl_b32 s73, s73, 10
  s_add_u32 s73, s73, 10485760
  s_waitcnt lgkmcnt(0)
  v_mov_b32 v26, 0x3fb8aa3b
  v_mov_b32 v28, 0.5
  v_mov_b32 v30, 1.0
  v_pk_fma_f32 v[64:65], v[32:33], v[18:19], v[64:65] op_sel_hi:[1,0,1]
  v_pk_fma_f32 v[66:67], v[34:35], v[18:19], v[66:67] op_sel_hi:[1,0,1]
  v_pk_fma_f32 v[68:69], v[36:37], v[18:19], v[68:69] op_sel_hi:[1,0,1]
  v_pk_fma_f32 v[70:71], v[38:39], v[18:19], v[70:71] op_sel_hi:[1,0,1]
  v_pk_fma_f32 v[72:73], v[40:41], v[18:19], v[72:73] op_sel_hi:[1,0,1]
  v_pk_fma_f32 v[74:75], v[42:43], v[18:19], v[74:75] op_sel_hi:[1,0,1]
  v_pk_fma_f32 v[76:77], v[44:45], v[18:19], v[76:77] op_sel_hi:[1,0,1]
  v_pk_fma_f32 v[78:79], v[46:47], v[18:19], v[78:79] op_sel_hi:[1,0,1]
  v_pk_fma_f32 v[64:65], v[64:65], v[18:19], v[48:49] op_sel:[0,1,0] op_sel_hi:[1,1,1]
  v_pk_fma_f32 v[66:67], v[66:67], v[18:19], v[50:51] op_sel:[0,1,0] op_sel_hi:[1,1,1]
  v_pk_fma_f32 v[68:69], v[68:69], v[18:19], v[52:53] op_sel:[0,1,0] op_sel_hi:[1,1,1]
  v_pk_fma_f32 v[70:71], v[70:71], v[18:19], v[54:55] op_sel:[0,1,0] op_sel_hi:[1,1,1]
  v_pk_fma_f32 v[72:73], v[72:73], v[18:19], v[56:57] op_sel:[0,1,0] op_sel_hi:[1,1,1]
  v_pk_fma_f32 v[74:75], v[74:75], v[18:19], v[58:59] op_sel:[0,1,0] op_sel_hi:[1,1,1]
  v_pk_fma_f32 v[76:77], v[76:77], v[18:19], v[60:61] op_sel:[0,1,0] op_sel_hi:[1,1,1]
  v_pk_fma_f32 v[78:79], v[78:79], v[18:19], v[62:63] op_sel:[0,1,0] op_sel_hi:[1,1,1]
  v_pk_mul_f32 v[32:33], v[64:65], v[26:27] op_sel_hi:[1,0]
  v_pk_mul_f32 v[34:35], v[66:67], v[26:27] op_sel_hi:[1,0]
  v_pk_mul_f32 v[36:37], v[68:69], v[26:27] op_sel_hi:[1,0]
  v_pk_mul_f32 v[38:39], v[70:71], v[26:27] op_sel_hi:[1,0]
  v_pk_mul_f32 v[40:41], v[72:73], v[26:27] op_sel_hi:[1,0]
  v_pk_mul_f32 v[42:43], v[74:75], v[26:27] op_sel_hi:[1,0]
  v_pk_mul_f32 v[44:45], v[76:77], v[26:27] op_sel_hi:[1,0]
  v_pk_mul_f32 v[46:47], v[78:79], v[26:27] op_sel_hi:[1,0]
  v_exp_f32 v32, v32
  v_exp_f32 v33, v33
  v_exp_f32 v34, v34
  v_exp_f32 v35, v35
  v_exp_f32 v36, v36
  v_exp_f32 v37, v37
  v_exp_f32 v38, v38
  v_exp_f32 v39, v39
  v_exp_f32 v40, v40
  v_exp_f32 v41, v41
  v_exp_f32 v42, v42
  v_exp_f32 v43, v43
  v_exp_f32 v44, v44
  v_exp_f32 v45, v45
  v_exp_f32 v46, v46
  v_exp_f32 v47, v47
  v_pk_fma_f32 v[48:49], v[32:33], v[28:29], v[30:31] op_sel_hi:[1,0,0]
  v_pk_fma_f32 v[50:51], v[34:35], v[28:29], v[30:31] op_sel_hi:[1,0,0]
  v_pk_fma_f32 v[52:53], v[36:37], v[28:29], v[30:31] op_sel_hi:[1,0,0]
  v_pk_fma_f32 v[54:55], v[38:39], v[28:29], v[30:31] op_sel_hi:[1,0,0]
  v_pk_fma_f32 v[56:57], v[40:41], v[28:29], v[30:31] op_sel_hi:[1,0,0]
  v_pk_fma_f32 v[58:59], v[42:43], v[28:29], v[30:31] op_sel_hi:[1,0,0]
  v_pk_fma_f32 v[60:61], v[44:45], v[28:29], v[30:31] op_sel_hi:[1,0,0]
  v_pk_fma_f32 v[62:63], v[46:47], v[28:29], v[30:31] op_sel_hi:[1,0,0]
  v_pk_fma_f32 v[48:49], v[48:49], v[32:33], v[30:31] op_sel_hi:[1,1,0]
  v_pk_fma_f32 v[50:51], v[50:51], v[34:35], v[30:31] op_sel_hi:[1,1,0]
  v_pk_fma_f32 v[52:53], v[52:53], v[36:37], v[30:31] op_sel_hi:[1,1,0]
  v_pk_fma_f32 v[54:55], v[54:55], v[38:39], v[30:31] op_sel_hi:[1,1,0]
  v_pk_fma_f32 v[56:57], v[56:57], v[40:41], v[30:31] op_sel_hi:[1,1,0]
  v_pk_fma_f32 v[58:59], v[58:59], v[42:43], v[30:31] op_sel_hi:[1,1,0]
  v_pk_fma_f32 v[60:61], v[60:61], v[44:45], v[30:31] op_sel_hi:[1,1,0]
  v_pk_fma_f32 v[62:63], v[62:63], v[46:47], v[30:31] op_sel_hi:[1,1,0]
  v_rcp_f32 v48, v48
  v_rcp_f32 v49, v49
  v_rcp_f32 v50, v50
  v_rcp_f32 v51, v51
  v_rcp_f32 v52, v52
  v_rcp_f32 v53, v53
  v_rcp_f32 v54, v54
  v_rcp_f32 v55, v55
  v_rcp_f32 v56, v56
  v_rcp_f32 v57, v57
  v_rcp_f32 v58, v58
  v_rcp_f32 v59, v59
  v_rcp_f32 v60, v60
  v_rcp_f32 v61, v61
  v_rcp_f32 v62, v62
  v_rcp_f32 v63, v63
  s_nop 0
  v_pk_fma_f32 v[64:65], v[64:65], v[48:49], v[64:65] neg_lo:[1,0,0] neg_hi:[1,0,0]
  v_pk_fma_f32 v[66:67], v[66:67], v[50:51], v[66:67] neg_lo:[1,0,0] neg_hi:[1,0,0]
  v_pk_fma_f32 v[68:69], v[68:69], v[52:53], v[68:69] neg_lo:[1,0,0] neg_hi:[1,0,0]
  v_pk_fma_f32 v[70:71], v[70:71], v[54:55], v[70:71] neg_lo:[1,0,0] neg_hi:[1,0,0]
  v_pk_fma_f32 v[72:73], v[72:73], v[56:57], v[72:73] neg_lo:[1,0,0] neg_hi:[1,0,0]
  v_pk_fma_f32 v[74:75], v[74:75], v[58:59], v[74:75] neg_lo:[1,0,0] neg_hi:[1,0,0]
  v_pk_fma_f32 v[76:77], v[76:77], v[60:61], v[76:77] neg_lo:[1,0,0] neg_hi:[1,0,0]
  v_pk_fma_f32 v[78:79], v[78:79], v[62:63], v[78:79] neg_lo:[1,0,0] neg_hi:[1,0,0]
  v_cvt_pk_bf16_f32 v64, v64, v65
  v_cvt_pk_bf16_f32 v65, v66, v67
  v_cvt_pk_bf16_f32 v66, v68, v69
  v_cvt_pk_bf16_f32 v67, v70, v71
  v_cvt_pk_bf16_f32 v68, v72, v73
  v_cvt_pk_bf16_f32 v69, v74, v75
  v_cvt_pk_bf16_f32 v70, v76, v77
  v_cvt_pk_bf16_f32 v71, v78, v79
  buffer_store_dwordx4 v[64:67], v16, s[20:23], s73 offen sc1
  buffer_store_dwordx4 v[68:71], v16, s[20:23], s73 offen offset:1024 sc1
  s_waitcnt lgkmcnt(0)
  s_barrier
  s_branch k1_phase2
k1_T1:
  s_waitcnt vmcnt(11)
  s_barrier
  ds_read_b128 v[128:131], v8 offset:0
  ds_read_b64_tr_b16 v[96:97], v12 offset:0
  ds_read_b64_tr_b16 v[98:99], v12 offset:512
  ds_read_b64_tr_b16 v[100:101], v13 offset:0
  ds_read_b64_tr_b16 v[102:103], v13 offset:512
  ds_read_b128 v[132:135], v9 offset:0
  ds_read_b64_tr_b16 v[104:105], v12 offset:2048
  ds_read_b64_tr_b16 v[106:107], v12 offset:2560
  ds_read_b64_tr_b16 v[108:109], v13 offset:2048
  ds_read_b64_tr_b16 v[110:111], v13 offset:2560
  s_waitcnt lgkmcnt(5)
  v_mfma_f32_32x32x16_bf16 v[64:79], v[96:99], v[128:131], v[64:79]
  ds_read_b128 v[136:139], v10 offset:0
  ds_read_b64_tr_b16 v[112:113], v12 offset:4096
  ds_read_b64_tr_b16 v[114:115], v12 offset:4608
  v_mfma_f32_32x32x16_bf16 v[80:95], v[100:103], v[128:131], v[80:95]
  ds_read_b64_tr_b16 v[116:117], v13 offset:4096
  ds_read_b64_tr_b16 v[118:119], v13 offset:4608
  s_waitcnt lgkmcnt(5)
  v_mfma_f32_32x32x16_bf16 v[64:79], v[104:107], v[132:135], v[64:79]
  ds_read_b128 v[140:143], v11 offset:0
  ds_read_b64_tr_b16 v[120:121], v12 offset:6144
  ds_read_b64_tr_b16 v[122:123], v12 offset:6656
  v_mfma_f32_32x32x16_bf16 v[80:95], v[108:111], v[132:135], v[80:95]
  ds_read_b64_tr_b16 v[124:125], v13 offset:6144
  ds_read_b64_tr_b16 v[126:127], v13 offset:6656
  s_waitcnt lgkmcnt(5)
  s_waitcnt vmcnt(4)
  s_barrier
  s_lshl_b32 s73, s56, 11
  s_add_u32 s73, s73, 71936
  v_add_u32 v24, s73, v14
  v_add_u32 v25, s73, v15
  ds_read_b64_tr_b16 v[60:61], v24 offset:0
  ds_read_b64_tr_b16 v[62:63], v24 offset:512
  ds_read_b64_tr_b16 v[28:29], v25 offset:0
  ds_read_b64_tr_b16 v[30:31], v25 offset:512
  v_mfma_f32_32x32x16_bf16 v[64:79], v[112:115], v[136:139], v[64:79]
  s_add_u32 m0, s64, 49152
  ds_read_b128 v[144:147], v8 offset:16384
  ds_read_b64_tr_b16 v[96:97], v12 offset:16384
  ds_read_b64_tr_b16 v[98:99], v12 offset:16896
  v_mfma_f32_32x32x16_bf16 v[80:95], v[116:119], v[136:139], v[80:95]
  ds_read_b64_tr_b16 v[100:101], v13 offset:16384
  ds_read_b64_tr_b16 v[102:103], v13 offset:16896
  buffer_load_dwordx4 v2, s[8:11], s63 offen lds
  v_lshlrev_b32 v36, 16, v32
  v_and_b32 v37, 0xffff0000, v32
  v_lshlrev_b32 v38, 16, v33
  v_and_b32 v39, 0xffff0000, v33
  v_lshlrev_b32 v40, 16, v34
  v_and_b32 v41, 0xffff0000, v34
  v_lshlrev_b32 v42, 16, v35
  v_and_b32 v43, 0xffff0000, v35
  v_add_f32 v44, v36, v37
  v_mul_f32 v45, v36, v36
  v_fma_f32 v45, v37, v37, v45
  v_add_f32 v44, v44, v38
  v_fma_f32 v45, v38, v38, v45
  v_add_f32 v44, v44, v39
  v_fma_f32 v45, v39, v39, v45
  s_waitcnt lgkmcnt(9)
  v_mfma_f32_32x32x16_bf16 v[64:79], v[120:123], v[140:143], v[64:79]
  ds_read_b128 v[148:151], v9 offset:16384
  ds_read_b64_tr_b16 v[104:105], v12 offset:18432
  ds_read_b64_tr_b16 v[106:107], v12 offset:18944
  v_mfma_f32_32x32x16_bf16 v[80:95], v[124:127], v[140:143], v[80:95]
  ds_read_b64_tr_b16 v[108:109], v13 offset:18432
  ds_read_b64_tr_b16 v[110:111], v13 offset:18944
  buffer_load_dwordx4 v3, s[8:11], s63 offen offset:1024 lds
  s_add_u32 s63, s63, 128
  v_add_f32 v44, v44, v40
  v_fma_f32 v45, v40, v40, v45
  v_add_f32 v44, v44, v41
  v_fma_f32 v45, v41, v41, v45
  v_add_f32 v44, v44, v42
  v_fma_f32 v45, v42, v42, v45
  v_add_f32 v44, v44, v43
  v_fma_f32 v45, v43, v43, v45
  s_nop 1
  v_add_f32_dpp v44, v44, v44 row_ror:8 row_mask:0xf bank_mask:0xf
  v_add_f32_dpp v45, v45, v45 row_ror:8 row_mask:0xf bank_mask:0xf
  s_nop 1
  v_add_f32_dpp v44, v44, v44 row_ror:4 row_mask:0xf bank_mask:0xf
  v_add_f32_dpp v45, v45, v45 row_ror:4 row_mask:0xf bank_mask:0xf
  s_nop 1
  v_mov_b32 v23, 0
  buffer_load_dword v23, v23, s[4:7], 0 offen sc1
  s_waitcnt lgkmcnt(5)
  v_mfma_f32_16x16x32_bf16 v[48:51], v[60:63], v[56:59], 0
  v_mfma_f32_16x16x32_bf16 v[52:55], v[28:31], v[56:59], 0
  v_mfma_f32_32x32x16_bf16 v[64:79], v[96:99], v[144:147], v[64:79]
  s_add_u32 m0, s66, 114688
  ds_read_b128 v[152:155], v10 offset:16384
  ds_read_b64_tr_b16 v[112:113], v12 offset:20480
  ds_read_b64_tr_b16 v[114:115], v12 offset:20992
  v_mfma_f32_32x32x16_bf16 v[80:95], v[100:103], v[144:147], v[80:95]
  ds_read_b64_tr_b16 v[116:117], v13 offset:20480
  ds_read_b64_tr_b16 v[118:119], v13 offset:20992
  buffer_load_dwordx4 v4, s[12:15], s65 offen lds
  v_add_f32_dpp v44, v44, v44 row_ror:2 row_mask:0xf bank_mask:0xf
  v_add_f32_dpp v45, v45, v45 row_ror:2 row_mask:0xf bank_mask:0xf
  s_nop 1
  v_add_f32_dpp v44, v44, v44 row_ror:1 row_mask:0xf bank_mask:0xf
  v_add_f32_dpp v45, v45, v45 row_ror:1 row_mask:0xf bank_mask:0xf
  v_mov_b32 v36, v44
  v_mov_b32 v37, v45
  s_nop 1
  v_permlane16_swap_b32 v44, v36
  v_permlane16_swap_b32 v45, v37
  s_nop 1
  v_add_f32 v44, v44, v36
  v_add_f32 v45, v45, v37
  v_mov_b32 v36, v44
  v_mov_b32 v37, v45
  v_and_b32 v27, 15, v0
  v_lshrrev_b32 v26, 4, v0
  v_lshlrev_b32 v26, 7, v26
  v_lshl_add_u32 v26, v27, 9, v26
  s_lshl_b32 s73, s56, 2
  s_add_u32 s73, s73, 135168
  v_add_u32 v26, s73, v26
  v_cmp_gt_u32 vcc, 2, v27
  s_and_saveexec_b64 s[74:75], vcc
  ds_write_b32 v26, v48 offset:0
  ds_write_b32 v26, v49 offset:32
  ds_write_b32 v26, v50 offset:64
  ds_write_b32 v26, v51 offset:96
  ds_write_b32 v26, v52 offset:1024
  ds_write_b32 v26, v53 offset:1056
  ds_write_b32 v26, v54 offset:1088
  ds_write_b32 v26, v55 offset:1120
  s_mov_b64 exec, s[74:75]
  buffer_load_ushort v21, v21, s[24:27], s32 offen
  s_waitcnt lgkmcnt(13)
  v_mfma_f32_32x32x16_bf16 v[64:79], v[104:107], v[148:151], v[64:79]
  ds_read_b128 v[156:159], v11 offset:16384
  ds_read_b64_tr_b16 v[120:121], v12 offset:22528
  ds_read_b64_tr_b16 v[122:123], v12 offset:23040
  v_mfma_f32_32x32x16_bf16 v[80:95], v[108:111], v[148:151], v[80:95]
  ds_read_b64_tr_b16 v[124:125], v13 offset:22528
  ds_read_b64_tr_b16 v[126:127], v13 offset:23040
  buffer_load_dwordx4 v5, s[12:15], s65 offen offset:1024 lds
  s_add_u32 s65, s65, s67
  s_nop 1
  v_permlane32_swap_b32 v44, v36
  v_permlane32_swap_b32 v45, v37
  s_nop 1
  v_add_f32 v44, v44, v36
  v_add_f32 v45, v45, v37
  v_mul_f32 v44, 0x3b000000, v44
  v_mul_f32 v45, 0x3b000000, v45
  v_fma_f32 v45, -v44, v44, v45
  v_max_f32 v45, 0, v45
  v_add_f32 v45, 0x3727c5ac, v45
  v_rsq_f32 v32, v45
  v_sub_f32 v33, 0, v44
  v_mul_f32 v34, v33, v32
  v_mov_b32 v35, 0
  s_lshl_b32 s73, s2, 3
  s_add_u32 s73, s73, s56
  s_lshl_b32 s73, s73, 4
  s_add_u32 s73, s73, 21004288
  v_mov_b32 v24, 0
  s_mov_b64 exec, 1
  buffer_store_dwordx4 v[32:35], v24, s[20:23], s73 offen sc1
  s_mov_b64 exec, -1
  s_waitcnt lgkmcnt(13)
  s_waitcnt lgkmcnt(5)
  s_waitcnt vmcnt(7)
  s_barrier
  v_lshlrev_b32 v24, 5, v0
  v_add_u32 v24, 135168, v24
  ds_read_b128 v[48:51], v24
  ds_read_b128 v[52:55], v24 offset:16
  v_mfma_f32_32x32x16_bf16 v[64:79], v[112:115], v[152:155], v[64:79]
  s_add_u32 m0, s64, 0
  ds_read_b128 v[160:163], v8 offset:32768
  ds_read_b64_tr_b16 v[96:97], v12 offset:32768
  ds_read_b64_tr_b16 v[98:99], v12 offset:33280
  v_mfma_f32_32x32x16_bf16 v[80:95], v[116:119], v[152:155], v[80:95]
  ds_read_b64_tr_b16 v[100:101], v13 offset:32768
  ds_read_b64_tr_b16 v[102:103], v13 offset:33280
  buffer_load_dwordx4 v2, s[8:11], s63 offen lds
  s_waitcnt lgkmcnt(7)
  v_mfma_f32_32x32x16_bf16 v[64:79], v[120:123], v[156:159], v[64:79]
  ds_read_b128 v[164:167], v9 offset:32768
  ds_read_b64_tr_b16 v[104:105], v12 offset:34816
  ds_read_b64_tr_b16 v[106:107], v12 offset:35328
  v_mfma_f32_32x32x16_bf16 v[80:95], v[124:127], v[156:159], v[80:95]
  ds_read_b64_tr_b16 v[108:109], v13 offset:34816
  ds_read_b64_tr_b16 v[110:111], v13 offset:35328
  buffer_load_dwordx4 v3, s[8:11], s63 offen offset:1024 lds
  s_add_u32 s63, s63, 128
  s_waitcnt lgkmcnt(10)
  v_add_f32 v48, v48, v52
  v_add_f32 v49, v49, v53
  v_add_f32 v50, v50, v54
  v_add_f32 v51, v51, v55
  s_lshl_b32 s73, s2, 8
  s_add_u32 s73, s73, 21069824
  s_cmp_lt_u32 s2, 208
  s_cselect_b32 s73, s73, 0x20000000
  v_add_f32 v48, v48, v49
  v_add_f32 v50, v50, v51
  s_cmp_eq_u32 s56, 0
  s_cselect_b32 s73, s73, 0x20000000
  v_lshlrev_b32 v24, 2, v0
  v_add_f32 v48, v48, v50
  buffer_store_dword v48, v24, s[20:23], s73 offen sc1
  s_waitcnt lgkmcnt(5)
  v_mfma_f32_32x32x16_bf16 v[64:79], v[96:99], v[160:163], v[64:79]
  s_add_u32 m0, s66, 65536
  ds_read_b128 v[168:171], v10 offset:32768
  ds_read_b64_tr_b16 v[112:113], v12 offset:36864
  ds_read_b64_tr_b16 v[114:115], v12 offset:37376
  v_mfma_f32_32x32x16_bf16 v[80:95], v[100:103], v[160:163], v[80:95]
  ds_read_b64_tr_b16 v[116:117], v13 offset:36864
  ds_read_b64_tr_b16 v[118:119], v13 offset:37376
  buffer_load_dwordx4 v4, s[12:15], s65 offen lds
  s_waitcnt lgkmcnt(5)
  v_mfma_f32_32x32x16_bf16 v[64:79], v[104:107], v[164:167], v[64:79]
  ds_read_b128 v[172:175], v11 offset:32768
  ds_read_b64_tr_b16 v[120:121], v12 offset:38912
  ds_read_b64_tr_b16 v[122:123], v12 offset:39424
  v_mfma_f32_32x32x16_bf16 v[80:95], v[108:111], v[164:167], v[80:95]
  ds_read_b64_tr_b16 v[124:125], v13 offset:38912
  ds_read_b64_tr_b16 v[126:127], v13 offset:39424
  buffer_load_dwordx4 v5, s[12:15], s65 offen offset:1024 lds
  s_add_u32 s65, s65, s67
  s_waitcnt lgkmcnt(5)
  s_waitcnt vmcnt(6)
  s_barrier
  v_mfma_f32_32x32x16_bf16 v[64:79], v[112:115], v[168:171], v[64:79]
  s_add_u32 m0, s64, 16384
  ds_read_b128 v[176:179], v8 offset:49152
  ds_read_b64_tr_b16 v[96:97], v12 offset:49152
  ds_read_b64_tr_b16 v[98:99], v12 offset:49664
  v_mfma_f32_32x32x16_bf16 v[80:95], v[116:119], v[168:171], v[80:95]
  ds_read_b64_tr_b16 v[100:101], v13 offset:49152
  ds_read_b64_tr_b16 v[102:103], v13 offset:49664
  buffer_load_dwordx4 v2, s[8:11], s63 offen lds
  s_waitcnt lgkmcnt(5)
  v_mfma_f32_32x32x16_bf16 v[64:79], v[120:123], v[172:175], v[64:79]
  ds_read_b128 v[180:183], v9 offset:49152
  ds_read_b64_tr_b16 v[104:105], v12 offset:51200
  ds_read_b64_tr_b16 v[106:107], v12 offset:51712
  v_mfma_f32_32x32x16_bf16 v[80:95], v[124:127], v[172:175], v[80:95]
  ds_read_b64_tr_b16 v[108:109], v13 offset:51200
  ds_read_b64_tr_b16 v[110:111], v13 offset:51712
  buffer_load_dwordx4 v3, s[8:11], s63 offen offset:1024 lds
  s_add_u32 s63, s63, 128
  s_waitcnt lgkmcnt(5)
  v_mfma_f32_32x32x16_bf16 v[64:79], v[96:99], v[176:179], v[64:79]
  s_add_u32 m0, s66, 81920
  ds_read_b128 v[184:187], v10 offset:49152
  ds_read_b64_tr_b16 v[112:113], v12 offset:53248
  ds_read_b64_tr_b16 v[114:115], v12 offset:53760
  v_mfma_f32_32x32x16_bf16 v[80:95], v[100:103], v[176:179], v[80:95]
  ds_read_b64_tr_b16 v[116:117], v13 offset:53248
  ds_read_b64_tr_b16 v[118:119], v13 offset:53760
  buffer_load_dwordx4 v4, s[12:15], s65 offen lds
  s_waitcnt lgkmcnt(5)
  v_mfma_f32_32x32x16_bf16 v[64:79], v[104:107], v[180:183], v[64:79]
  ds_read_b128 v[188:191], v11 offset:49152
  ds_read_b64_tr_b16 v[120:121], v12 offset:55296
  ds_read_b64_tr_b16 v[122:123], v12 offset:55808
  v_mfma_f32_32x32x16_bf16 v[80:95], v[108:111], v[180:183], v[80:95]
  ds_read_b64_tr_b16 v[124:125], v13 offset:55296
  ds_read_b64_tr_b16 v[126:127], v13 offset:55808
  buffer_load_dwordx4 v5, s[12:15], s65 offen offset:1024 lds
  s_add_u32 s65, s65, s67
  s_waitcnt lgkmcnt(5)
  s_waitcnt vmcnt(4)
  s_barrier
  v_readfirstlane_b32 s90, v23
  s_mov_b32 s77, 0
k1_nqT1:
  s_cmp_lg_u32 s90, 0
  s_cbranch_scc1 k1_nokT1
  v_mov_b32 v23, 0
  buffer_load_dword v23, v23, s[4:7], 0 offen sc1
  s_waitcnt vmcnt(0)
  v_readfirstlane_b32 s90, v23
  s_add_u32 s77, s77, 1
  s_cmp_lt_u32 s77, 200000
  s_cbranch_scc1 k1_nqT1
k1_nokT1:
  s_cmp_eq_u32 s56, 0
  s_cbranch_scc0 k1_pfT1
  s_lshl_b32 s73, s2, 2
  s_add_u32 s73, s73, 20987904
  v_mov_b32 v24, s90
  v_mov_b32 v25, 0
  s_mov_b64 exec, 1
  buffer_store_dword v24, v25, s[20:23], s73 offen sc1
  s_mov_b64 exec, -1
k1_pfT1:
  v_mfma_f32_32x32x16_bf16 v[64:79], v[112:115], v[184:187], v[64:79]
  s_add_u32 m0, s64, 32768
  ds_read_b128 v[192:195], v8 offset:0
  ds_read_b64_tr_b16 v[96:97], v12 offset:0
  ds_read_b64_tr_b16 v[98:99], v12 offset:512
  v_mfma_f32_32x32x16_bf16 v[80:95], v[116:119], v[184:187], v[80:95]
  ds_read_b64_tr_b16 v[100:101], v13 offset:0
  ds_read_b64_tr_b16 v[102:103], v13 offset:512
  buffer_load_dwordx4 v2, s[8:11], s63 offen lds
  v_lshlrev_b32 v21, 16, v21
  v_and_b32 v24, 31, v0
  s_lshl_b32 s73, s56, 7
  s_add_u32 s73, s73, 134144
  v_lshl_add_u32 v24, v24, 2, s73
  ds_write_b32 v24, v21
  s_waitcnt lgkmcnt(6)
  v_mfma_f32_32x32x16_bf16 v[64:79], v[120:123], v[188:191], v[64:79]
  ds_read_b128 v[196:199], v9 offset:0
  ds_read_b64_tr_b16 v[104:105], v12 offset:2048
  ds_read_b64_tr_b16 v[106:107], v12 offset:2560
  v_mfma_f32_32x32x16_bf16 v[80:95], v[124:127], v[188:191], v[80:95]
  ds_read_b64_tr_b16 v[108:109], v13 offset:2048
  ds_read_b64_tr_b16 v[110:111], v13 offset:2560
  buffer_load_dwordx4 v3, s[8:11], s63 offen offset:1024 lds
  s_add_u32 s63, s63, 128
  s_waitcnt lgkmcnt(6)
  v_mfma_f32_32x32x16_bf16 v[64:79], v[96:99], v[192:195], v[64:79]
  s_add_u32 m0, s66, 98304
  ds_read_b128 v[200:203], v10 offset:0
  ds_read_b64_tr_b16 v[112:113], v12 offset:4096
  ds_read_b64_tr_b16 v[114:115], v12 offset:4608
  v_mfma_f32_32x32x16_bf16 v[80:95], v[100:103], v[192:195], v[80:95]
  ds_read_b64_tr_b16 v[116:117], v13 offset:4096
  ds_read_b64_tr_b16 v[118:119], v13 offset:4608
  buffer_load_dwordx4 v4, s[12:15], s65 offen lds
  s_waitcnt lgkmcnt(5)
  v_mfma_f32_32x32x16_bf16 v[64:79], v[104:107], v[196:199], v[64:79]
  ds_read_b128 v[204:207], v11 offset:0
  ds_read_b64_tr_b16 v[120:121], v12 offset:6144
  ds_read_b64_tr_b16 v[122:123], v12 offset:6656
  v_mfma_f32_32x32x16_bf16 v[80:95], v[108:111], v[196:199], v[80:95]
  ds_read_b64_tr_b16 v[124:125], v13 offset:6144
  ds_read_b64_tr_b16 v[126:127], v13 offset:6656
  buffer_load_dwordx4 v5, s[12:15], s65 offen offset:1024 lds
  s_add_u32 s65, s65, s67
  s_waitcnt lgkmcnt(5)
  s_waitcnt vmcnt(4)
  s_barrier
  v_mfma_f32_32x32x16_bf16 v[64:79], v[112:115], v[200:203], v[64:79]
  s_add_u32 m0, s64, 49152
  ds_read_b128 v[208:211], v8 offset:16384
  ds_read_b64_tr_b16 v[96:97], v12 offset:16384
  ds_read_b64_tr_b16 v[98:99], v12 offset:16896
  v_mfma_f32_32x32x16_bf16 v[80:95], v[116:119], v[200:203], v[80:95]
  ds_read_b64_tr_b16 v[100:101], v13 offset:16384
  ds_read_b64_tr_b16 v[102:103], v13 offset:16896
  buffer_load_dwordx4 v2, s[8:11], s63 offen lds
  s_waitcnt lgkmcnt(5)
  v_mfma_f32_32x32x16_bf16 v[64:79], v[120:123], v[204:207], v[64:79]
  ds_read_b128 v[212:215], v9 offset:16384
  ds_read_b64_tr_b16 v[104:105], v12 offset:18432
  ds_read_b64_tr_b16 v[106:107], v12 offset:18944
  v_mfma_f32_32x32x16_bf16 v[80:95], v[124:127], v[204:207], v[80:95]
  ds_read_b64_tr_b16 v[108:109], v13 offset:18432
  ds_read_b64_tr_b16 v[110:111], v13 offset:18944
  buffer_load_dwordx4 v3, s[8:11], s63 offen offset:1024 lds
  s_add_u32 s63, s63, 128
  s_waitcnt lgkmcnt(5)
  v_mfma_f32_32x32x16_bf16 v[64:79], v[96:99], v[208:211], v[64:79]
  s_add_u32 m0, s66, 114688
  ds_read_b128 v[216:219], v10 offset:16384
  ds_read_b64_tr_b16 v[112:113], v12 offset:20480
  ds_read_b64_tr_b16 v[114:115], v12 offset:20992
  v_mfma_f32_32x32x16_bf16 v[80:95], v[100:103], v[208:211], v[80:95]
  ds_read_b64_tr_b16 v[116:117], v13 offset:20480
  ds_read_b64_tr_b16 v[118:119], v13 offset:20992
  buffer_load_dwordx4 v4, s[12:15], s65 offen lds
  s_waitcnt lgkmcnt(5)
  v_mfma_f32_32x32x16_bf16 v[64:79], v[104:107], v[212:215], v[64:79]
  ds_read_b128 v[220:223], v11 offset:16384
  ds_read_b64_tr_b16 v[120:121], v12 offset:22528
  ds_read_b64_tr_b16 v[122:123], v12 offset:23040
  v_mfma_f32_32x32x16_bf16 v[80:95], v[108:111], v[212:215], v[80:95]
  ds_read_b64_tr_b16 v[124:125], v13 offset:22528
  ds_read_b64_tr_b16 v[126:127], v13 offset:23040
  buffer_load_dwordx4 v5, s[12:15], s65 offen offset:1024 lds
  s_add_u32 s65, s65, s67
  buffer_load_dword v31, v46, s[20:23], 0 offen sc1
  s_waitcnt lgkmcnt(5)
  s_waitcnt vmcnt(5)
  s_barrier
  v_mfma_f32_32x32x16_bf16 v[64:79], v[112:115], v[216:219], v[64:79]
  s_add_u32 m0, s69, 65536
  ds_read_b128 v[224:227], v8 offset:32768
  ds_read_b64_tr_b16 v[96:97], v12 offset:32768
  ds_read_b64_tr_b16 v[98:99], v12 offset:33280
  v_mfma_f32_32x32x16_bf16 v[80:95], v[116:119], v[216:219], v[80:95]
  ds_read_b64_tr_b16 v[100:101], v13 offset:32768
  ds_read_b64_tr_b16 v[102:103], v13 offset:33280
  buffer_load_dwordx4 v6, s[16:19], s68 offen lds
  s_waitcnt lgkmcnt(5)
  v_mfma_f32_32x32x16_bf16 v[64:79], v[120:123], v[220:223], v[64:79]
  ds_read_b128 v[228:231], v9 offset:32768
  ds_read_b64_tr_b16 v[104:105], v12 offset:34816
  ds_read_b64_tr_b16 v[106:107], v12 offset:35328
  v_mfma_f32_32x32x16_bf16 v[80:95], v[124:127], v[220:223], v[80:95]
  ds_read_b64_tr_b16 v[108:109], v13 offset:34816
  ds_read_b64_tr_b16 v[110:111], v13 offset:35328
  buffer_load_dwordx4 v7, s[16:19], s68 offen offset:1024 lds
  s_add_u32 s68, s68, 458752
  s_waitcnt lgkmcnt(5)
  v_mfma_f32_32x32x16_bf16 v[64:79], v[96:99], v[224:227], v[64:79]
  s_add_u32 m0, s69, 0
  ds_read_b128 v[232:235], v10 offset:32768
  ds_read_b64_tr_b16 v[112:113], v12 offset:36864
  ds_read_b64_tr_b16 v[114:115], v12 offset:37376
  v_mfma_f32_32x32x16_bf16 v[80:95], v[100:103], v[224:227], v[80:95]
  ds_read_b64_tr_b16 v[116:117], v13 offset:36864
  ds_read_b64_tr_b16 v[118:119], v13 offset:37376
  buffer_load_dwordx4 v6, s[16:19], s70 offen lds
  s_waitcnt lgkmcnt(5)
  v_mfma_f32_32x32x16_bf16 v[64:79], v[104:107], v[228:231], v[64:79]
  ds_read_b128 v[236:239], v11 offset:32768
  ds_read_b64_tr_b16 v[120:121], v12 offset:38912
  ds_read_b64_tr_b16 v[122:123], v12 offset:39424
  v_mfma_f32_32x32x16_bf16 v[80:95], v[108:111], v[228:231], v[80:95]
  ds_read_b64_tr_b16 v[124:125], v13 offset:38912
  ds_read_b64_tr_b16 v[126:127], v13 offset:39424
  buffer_load_dwordx4 v7, s[16:19], s70 offen offset:1024 lds
  s_add_u32 s70, s70, 458752
  s_waitcnt lgkmcnt(5)
  s_waitcnt vmcnt(5)
  s_barrier
  s_waitcnt vmcnt(4)
  s_mov_b32 s77, 0
k1_cpT1:
  v_cmp_eq_u32 vcc, s90, v31
  s_add_u32 s77, s77, 1
  s_cmp_eq_u64 vcc, exec
  s_cbranch_scc1 k1_cfT1
  s_cmp_gt_u32 s77, 200000
  s_cbranch_scc1 k1_cfT1
  buffer_load_dword v31, v46, s[20:23], 0 offen sc1
  s_waitcnt vmcnt(0)
  s_branch k1_cpT1
k1_cfT1:
  buffer_load_dwordx4 v[32:35], v16, s[20:23], s92 offen sc1
  buffer_load_dword v36, v47, s[20:23], s93 offen offset:0 sc1
  buffer_load_dword v37, v47, s[20:23], s93 offen offset:256 sc1
  buffer_load_dword v38, v47, s[20:23], s93 offen offset:512 sc1
  buffer_load_dword v39, v47, s[20:23], s93 offen offset:768 sc1
  v_mfma_f32_32x32x16_bf16 v[64:79], v[112:115], v[232:235], v[64:79]
  s_add_u32 m0, s69, 81920
  ds_read_b128 v[240:243], v8 offset:49152
  ds_read_b64_tr_b16 v[96:97], v12 offset:49152
  ds_read_b64_tr_b16 v[98:99], v12 offset:49664
  v_mfma_f32_32x32x16_bf16 v[80:95], v[116:119], v[232:235], v[80:95]
  ds_read_b64_tr_b16 v[100:101], v13 offset:49152
  ds_read_b64_tr_b16 v[102:103], v13 offset:49664
  buffer_load_dwordx4 v6, s[16:19], s68 offen lds
  s_waitcnt lgkmcnt(5)
  v_mfma_f32_32x32x16_bf16 v[64:79], v[120:123], v[236:239], v[64:79]
  ds_read_b128 v[244:247], v9 offset:49152
  ds_read_b64_tr_b16 v[104:105], v12 offset:51200
  ds_read_b64_tr_b16 v[106:107], v12 offset:51712
  v_mfma_f32_32x32x16_bf16 v[80:95], v[124:127], v[236:239], v[80:95]
  ds_read_b64_tr_b16 v[108:109], v13 offset:51200
  ds_read_b64_tr_b16 v[110:111], v13 offset:51712
  buffer_load_dwordx4 v7, s[16:19], s68 offen offset:1024 lds
  s_add_u32 s68, s68, 458752
  s_waitcnt lgkmcnt(5)
  v_mfma_f32_32x32x16_bf16 v[64:79], v[96:99], v[240:243], v[64:79]
  s_add_u32 m0, s69, 16384
  ds_read_b128 v[248:251], v10 offset:49152
  ds_read_b64_tr_b16 v[112:113], v12 offset:53248
  ds_read_b64_tr_b16 v[114:115], v12 offset:53760
  v_mfma_f32_32x32x16_bf16 v[80:95], v[100:103], v[240:243], v[80:95]
  ds_read_b64_tr_b16 v[116:117], v13 offset:53248
  ds_read_b64_tr_b16 v[118:119], v13 offset:53760
  buffer_load_dwordx4 v6, s[16:19], s70 offen lds
  s_waitcnt lgkmcnt(5)
  v_mfma_f32_32x32x16_bf16 v[64:79], v[104:107], v[244:247], v[64:79]
  ds_read_b128 v[252:255], v11 offset:49152
  ds_read_b64_tr_b16 v[120:121], v12 offset:55296
  ds_read_b64_tr_b16 v[122:123], v12 offset:55808
  v_mfma_f32_32x32x16_bf16 v[80:95], v[108:111], v[244:247], v[80:95]
  ds_read_b64_tr_b16 v[124:125], v13 offset:55296
  ds_read_b64_tr_b16 v[126:127], v13 offset:55808
  buffer_load_dwordx4 v7, s[16:19], s70 offen offset:1024 lds
  s_add_u32 s70, s70, 458752
  s_waitcnt lgkmcnt(5)
  s_barrier
  v_mfma_f32_32x32x16_bf16 v[64:79], v[112:115], v[248:251], v[64:79]
  s_add_u32 m0, s69, 98304
  v_mfma_f32_32x32x16_bf16 v[80:95], v[116:119], v[248:251], v[80:95]
  s_nop 0
  buffer_load_dwordx4 v6, s[16:19], s68 offen lds
  s_waitcnt lgkmcnt(0)
  v_mfma_f32_32x32x16_bf16 v[64:79], v[120:123], v[252:255], v[64:79]
  v_mfma_f32_32x32x16_bf16 v[80:95], v[124:127], v[252:255], v[80:95]
  buffer_load_dwordx4 v7, s[16:19], s68 offen offset:1024 lds
  s_add_u32 s68, s68, 458752
  s_add_u32 m0, s69, 32768
  s_nop 0
  buffer_load_dwordx4 v6, s[16:19], s70 offen lds
  buffer_load_dwordx4 v7, s[16:19], s70 offen offset:1024 lds
  s_add_u32 s70, s70, 458752
  s_waitcnt vmcnt(8)
  v_add_f32 v36, v36, v37
  v_add_f32 v38, v38, v39
  s_and_b32 s73, s56, 1
  s_lshl_b32 s73, s73, 8
  s_add_u32 s73, s73, 131072
  v_lshl_add_u32 v24, v0, 2, s73
  v_add_f32 v36, v36, v38
  ds_write_b32 v24, v32
  ds_write_b32 v24, v33 offset:512
  ds_write_b32 v24, v34 offset:1024
  s_lshl_b32 s73, s57, 8
  s_add_u32 s73, s73, 133120
  v_lshl_add_u32 v24, v0, 2, s73
  ds_write_b32 v24, v36
  v_and_b32 v24, 31, v0
  s_lshl_b32 s72, s57, 7
  s_add_u32 s72, s72, 131072
  v_lshl_add_u32 v23, v24, 2, s72
  s_waitcnt lgkmcnt(0)
  s_barrier
  s_add_u32 m0, s69, 114688
  s_nop 0
  buffer_load_dwordx4 v6, s[16:19], s68 offen lds
  buffer_load_dwordx4 v7, s[16:19], s68 offen offset:1024 lds
  s_add_u32 s68, s68, 458752
  s_add_u32 m0, s69, 49152
  s_nop 0
  buffer_load_dwordx4 v6, s[16:19], s70 offen lds
  buffer_load_dwordx4 v7, s[16:19], s70 offen offset:1024 lds
  s_add_u32 s70, s70, 458752
  ds_read_b32 v19, v23
  ds_read_b32 v18, v23 offset:512
  s_cmp_eq_u32 s61, 1
  s_cbranch_scc1 k1_YB
  v_lshrrev_b32 v24, 5, v0
  v_lshlrev_b32 v24, 4, v24
  v_add_u32 v24, 133376, v24
  ds_read_b128 v[32:35], v24 offset:0
  ds_read_b128 v[36:39], v24 offset:32
  ds_read_b128 v[40:43], v24 offset:64
  ds_read_b128 v[44:47], v24 offset:96
  s_lshl_b32 s73, s60, 2
  s_add_u32 s73, s73, 0
  s_lshl_b32 s73, s73, 16
  s_lshl_b32 s74, s62, 10
  s_add_u32 s73, s73, s74
  s_add_u32 s73, s73, 2097152
  s_add_u32 s74, s73, 65536
  s_waitcnt lgkmcnt(0)
  v_mov_b32 v30, v19
  v_pk_fma_f32 v[64:65], v[32:33], v[18:19], v[64:65] op_sel_hi:[1,0,1]
  v_pk_fma_f32 v[66:67], v[34:35], v[18:19], v[66:67] op_sel_hi:[1,0,1]
  v_pk_fma_f32 v[68:69], v[36:37], v[18:19], v[68:69] op_sel_hi:[1,0,1]
  v_pk_fma_f32 v[70:71], v[38:39], v[18:19], v[70:71] op_sel_hi:[1,0,1]
  v_pk_fma_f32 v[72:73], v[40:41], v[18:19], v[72:73] op_sel_hi:[1,0,1]
  v_pk_fma_f32 v[74:75], v[42:43], v[18:19], v[74:75] op_sel_hi:[1,0,1]
  v_pk_fma_f32 v[76:77], v[44:45], v[18:19], v[76:77] op_sel_hi:[1,0,1]
  v_pk_fma_f32 v[78:79], v[46:47], v[18:19], v[78:79] op_sel_hi:[1,0,1]
  v_pk_mul_f32 v[64:65], v[64:65], v[30:31] op_sel_hi:[1,0]
  v_pk_mul_f32 v[66:67], v[66:67], v[30:31] op_sel_hi:[1,0]
  v_pk_mul_f32 v[68:69], v[68:69], v[30:31] op_sel_hi:[1,0]
  v_pk_mul_f32 v[70:71], v[70:71], v[30:31] op_sel_hi:[1,0]
  v_pk_mul_f32 v[72:73], v[72:73], v[30:31] op_sel_hi:[1,0]
  v_pk_mul_f32 v[74:75], v[74:75], v[30:31] op_sel_hi:[1,0]
  v_pk_mul_f32 v[76:77], v[76:77], v[30:31] op_sel_hi:[1,0]
  v_pk_mul_f32 v[78:79], v[78:79], v[30:31] op_sel_hi:[1,0]
  v_pk_mul_f32 v[24:25], v[64:65], v[64:65]
  v_pk_fma_f32 v[24:25], v[66:67], v[66:67], v[24:25]
  v_pk_fma_f32 v[24:25], v[68:69], v[68:69], v[24:25]
  v_pk_fma_f32 v[24:25], v[70:71], v[70:71], v[24:25]
  v_pk_mul_f32 v[26:27], v[72:73], v[72:73]
  v_pk_fma_f32 v[26:27], v[74:75], v[74:75], v[26:27]
  v_pk_fma_f32 v[26:27], v[76:77], v[76:77], v[26:27]
  v_pk_fma_f32 v[26:27], v[78:79], v[78:79], v[26:27]
  v_add_f32 v24, v24, v25
  v_add_f32 v26, v26, v27
  v_max3_f32 v22, v24, v26, v22
  v_cvt_pk_bf16_f32 v64, v64, v65
  v_cvt_pk_bf16_f32 v65, v66, v67
  v_cvt_pk_bf16_f32 v66, v68, v69
  v_cvt_pk_bf16_f32 v67, v70, v71
  v_cvt_pk_bf16_f32 v68, v72, v73
  v_cvt_pk_bf16_f32 v69, v74, v75
  v_cvt_pk_bf16_f32 v70, v76, v77
  v_cvt_pk_bf16_f32 v71, v78, v79
  buffer_store_dwordx4 v[64:67], v16, s[20:23], s73 offen sc1
  buffer_store_dwordx4 v[68:71], v16, s[20:23], s74 offen sc1
  v_lshrrev_b32 v24, 5, v0
  v_lshlrev_b32 v24, 4, v24
  v_add_u32 v24, 133504, v24
  ds_read_b128 v[32:35], v24 offset:0
  ds_read_b128 v[36:39], v24 offset:32
  ds_read_b128 v[40:43], v24 offset:64
  ds_read_b128 v[44:47], v24 offset:96
  s_lshl_b32 s73, s60, 2
  s_add_u32 s73, s73, 2
  s_lshl_b32 s73, s73, 16
  s_lshl_b32 s74, s62, 10
  s_add_u32 s73, s73, s74
  s_add_u32 s73, s73, 2097152
  s_add_u32 s74, s73, 65536
  s_waitcnt lgkmcnt(0)
  v_mov_b32 v30, v19
  v_pk_fma_f32 v[80:81], v[32:33], v[18:19], v[80:81] op_sel_hi:[1,0,1]
  v_pk_fma_f32 v[82:83], v[34:35], v[18:19], v[82:83] op_sel_hi:[1,0,1]
  v_pk_fma_f32 v[84:85], v[36:37], v[18:19], v[84:85] op_sel_hi:[1,0,1]
  v_pk_fma_f32 v[86:87], v[38:39], v[18:19], v[86:87] op_sel_hi:[1,0,1]
  v_pk_fma_f32 v[88:89], v[40:41], v[18:19], v[88:89] op_sel_hi:[1,0,1]
  v_pk_fma_f32 v[90:91], v[42:43], v[18:19], v[90:91] op_sel_hi:[1,0,1]
  v_pk_fma_f32 v[92:93], v[44:45], v[18:19], v[92:93] op_sel_hi:[1,0,1]
  v_pk_fma_f32 v[94:95], v[46:47], v[18:19], v[94:95] op_sel_hi:[1,0,1]
  v_pk_mul_f32 v[80:81], v[80:81], v[30:31] op_sel_hi:[1,0]
  v_pk_mul_f32 v[82:83], v[82:83], v[30:31] op_sel_hi:[1,0]
  v_pk_mul_f32 v[84:85], v[84:85], v[30:31] op_sel_hi:[1,0]
  v_pk_mul_f32 v[86:87], v[86:87], v[30:31] op_sel_hi:[1,0]
  v_pk_mul_f32 v[88:89], v[88:89], v[30:31] op_sel_hi:[1,0]
  v_pk_mul_f32 v[90:91], v[90:91], v[30:31] op_sel_hi:[1,0]
  v_pk_mul_f32 v[92:93], v[92:93], v[30:31] op_sel_hi:[1,0]
  v_pk_mul_f32 v[94:95], v[94:95], v[30:31] op_sel_hi:[1,0]
  v_pk_mul_f32 v[24:25], v[80:81], v[80:81]
  v_pk_fma_f32 v[24:25], v[82:83], v[82:83], v[24:25]
  v_pk_fma_f32 v[24:25], v[84:85], v[84:85], v[24:25]
  v_pk_fma_f32 v[24:25], v[86:87], v[86:87], v[24:25]
  v_pk_mul_f32 v[26:27], v[88:89], v[88:89]
  v_pk_fma_f32 v[26:27], v[90:91], v[90:91], v[26:27]
  v_pk_fma_f32 v[26:27], v[92:93], v[92:93], v[26:27]
  v_pk_fma_f32 v[26:27], v[94:95], v[94:95], v[26:27]
  v_add_f32 v24, v24, v25
  v_add_f32 v26, v26, v27
  v_max3_f32 v22, v24, v26, v22
  v_cvt_pk_bf16_f32 v80, v80, v81
  v_cvt_pk_bf16_f32 v81, v82, v83
  v_cvt_pk_bf16_f32 v82, v84, v85
  v_cvt_pk_bf16_f32 v83, v86, v87
  v_cvt_pk_bf16_f32 v84, v88, v89
  v_cvt_pk_bf16_f32 v85, v90, v91
  v_cvt_pk_bf16_f32 v86, v92, v93
  v_cvt_pk_bf16_f32 v87, v94, v95
  buffer_store_dwordx4 v[80:83], v16, s[20:23], s73 offen sc1
  buffer_store_dwordx4 v[84:87], v16, s[20:23], s74 offen sc1
  s_nop 1
  v_max_f32_dpp v22, v22, v22 row_ror:8 row_mask:0xf bank_mask:0xf
  s_nop 1
  v_max_f32_dpp v22, v22, v22 row_ror:4 row_mask:0xf bank_mask:0xf
  s_nop 1
  v_max_f32_dpp v22, v22, v22 row_ror:2 row_mask:0xf bank_mask:0xf
  s_nop 1
  v_max_f32_dpp v22, v22, v22 row_ror:1 row_mask:0xf bank_mask:0xf
  v_mov_b32 v24, v22
  s_nop 1
  v_permlane16_swap_b32 v22, v24
  s_nop 1
  v_max_f32 v22, v22, v24
  v_mov_b32 v24, v22
  s_nop 1
  v_permlane32_swap_b32 v22, v24
  s_nop 1
  v_max_f32 v22, v22, v24
  s_lshl_b32 s73, s60, 6
  s_add_u32 s73, s73, s62
  s_lshl_b32 s73, s73, 2
  s_add_u32 s73, s73, 6293504
  v_mov_b32 v24, 0
  buffer_store_dword v22, v24, s[20:23], s73 offen sc1
  s_waitcnt vmcnt(5)
  s_barrier
  s_waitcnt vmcnt(0)
  v_mov_b32 v24, 137216
  v_mov_b32 v25, 1
  s_mov_b64 exec, 1
  ds_add_rtn_u32 v26, v24, v25
  s_mov_b64 exec, -1
  s_lshl_b32 s73, s60, 5
  s_lshl_b32 s74, s61, 4
  s_add_u32 s73, s73, s74
  s_add_u32 s73, s73, s59
  s_lshl_b32 s73, s73, 2
  s_add_u32 s73, s73, 20975616
  s_waitcnt lgkmcnt(0)
  v_readfirstlane_b32 s74, v26
  s_cmp_eq_u32 s74, 7
  s_cbranch_scc0 k1_p1xb
  v_mov_b32 v24, s90
  v_mov_b32 v25, 0
  s_mov_b64 exec, 1
  buffer_store_dword v24, v25, s[20:23], s73 offen sc1
  s_mov_b64 exec, -1
k1_p1xb:
  s_lshl_b32 s72, s57, 8
  s_add_u32 s72, s72, s2
  s_lshr_b32 s73, s72, 3
  s_and_b32 s74, s72, 7
  s_cmp_lt_u32 s73, 112
  s_cselect_b32 s28, s48, s40
  s_cselect_b32 s29, s49, s41
  s_mov_b32 s30, 524288
  s_cselect_b32 s30, 1835008, s30
  s_cselect_b32 s75, 0, 112
  s_and_b32 s29, s29, 0xffff
  s_mov_b32 s31, 0x00020000
  s_sub_u32 s75, s73, s75
  s_lshl_b32 s75, s75, 14
  s_lshl_b32 s76, s74, 7
  s_add_u32 s75, s75, s76
  s_mul_i32 s80, s74, 288
  s_add_u32 s80, s80, s73
  s_lshl_b32 s80, s80, 10
  s_add_u32 s80, s80, 7340032
  s_cmp_lt_u32 s72, 1152
  s_cselect_b32 s80, s80, 0x20000000
  s_cselect_b32 s75, s75, 0x20000000
  v_lshrrev_b32 v24, 3, v0
  v_and_b32 v25, 7, v0
  v_bfe_u32 v26, v0, 4, 1
  v_lshlrev_b32 v26, 2, v26
  v_xor_b32 v25, v25, v26
  v_lshlrev_b32 v25, 4, v25
  v_lshl_add_u32 v24, v24, 10, v25
  v_add_u32 v25, 7168, v24
  s_xor_b32 s76, s64, 0
  s_add_u32 m0, s76, 137472
  s_nop 0
  buffer_load_dwordx4 v24, s[28:31], s75 offen lds
  buffer_load_dwordx4 v25, s[28:31], s75 offen offset:1024 lds
  s_add_u32 s72, s2, 1024
  s_cmp_eq_u32 s57, 0
  s_cselect_b32 s72, s72, 0x7fff
  s_lshr_b32 s73, s72, 3
  s_and_b32 s74, s72, 7
  s_cmp_lt_u32 s73, 112
  s_cselect_b32 s28, s48, s40
  s_cselect_b32 s29, s49, s41
  s_mov_b32 s30, 524288
  s_cselect_b32 s30, 1835008, s30
  s_cselect_b32 s75, 0, 112
  s_and_b32 s29, s29, 0xffff
  s_mov_b32 s31, 0x00020000
  s_sub_u32 s75, s73, s75
  s_lshl_b32 s75, s75, 14
  s_lshl_b32 s76, s74, 7
  s_add_u32 s75, s75, s76
  s_mul_i32 s33, s74, 288
  s_add_u32 s33, s33, s73
  s_lshl_b32 s33, s33, 10
  s_add_u32 s33, s33, 7340032
  s_cmp_lt_u32 s72, 1152
  s_cselect_b32 s33, s33, 0x20000000
  s_cselect_b32 s75, s75, 0x20000000
  v_lshrrev_b32 v24, 3, v0
  v_and_b32 v25, 7, v0
  v_bfe_u32 v26, v0, 4, 1
  v_lshlrev_b32 v26, 2, v26
  v_xor_b32 v25, v25, v26
  v_lshlrev_b32 v25, 4, v25
  v_lshl_add_u32 v24, v24, 10, v25
  v_add_u32 v25, 7168, v24
  s_xor_b32 s76, s64, 8192
  s_add_u32 m0, s76, 137472
  s_nop 0
  buffer_load_dwordx4 v24, s[28:31], s75 offen lds
  buffer_load_dwordx4 v25, s[28:31], s75 offen offset:1024 lds
  s_add_u32 s83, s81, 64
  s_lshr_b32 s83, s83, 1
  ds_read_b64_tr_b16 v[96:97], v15 offset:0
  ds_read_b64_tr_b16 v[98:99], v15 offset:512
  ds_read_b64_tr_b16 v[100:101], v15 offset:2048
  ds_read_b64_tr_b16 v[102:103], v15 offset:2560
  ds_read_b64_tr_b16 v[104:105], v15 offset:4096
  ds_read_b64_tr_b16 v[106:107], v15 offset:4608
  s_waitcnt lgkmcnt(4)
  v_mfma_f32_32x32x16_bf16 v[64:79], v[96:99], v[128:131], 0
  ds_read_b64_tr_b16 v[108:109], v15 offset:6144
  ds_read_b64_tr_b16 v[110:111], v15 offset:6656
  s_waitcnt lgkmcnt(4)
  v_mfma_f32_32x32x16_bf16 v[64:79], v[100:103], v[132:135], v[64:79]
  ds_read_b64_tr_b16 v[96:97], v15 offset:8192
  ds_read_b64_tr_b16 v[98:99], v15 offset:8704
  s_waitcnt lgkmcnt(4)
  v_mfma_f32_32x32x16_bf16 v[64:79], v[104:107], v[136:139], v[64:79]
  ds_read_b64_tr_b16 v[100:101], v15 offset:10240
  ds_read_b64_tr_b16 v[102:103], v15 offset:10752
  s_waitcnt lgkmcnt(4)
  v_mfma_f32_32x32x16_bf16 v[64:79], v[108:111], v[140:143], v[64:79]
  ds_read_b64_tr_b16 v[104:105], v15 offset:12288
  ds_read_b64_tr_b16 v[106:107], v15 offset:12800
  s_waitcnt lgkmcnt(4)
  v_mfma_f32_32x32x16_bf16 v[64:79], v[96:99], v[144:147], v[64:79]
  ds_read_b64_tr_b16 v[108:109], v15 offset:14336
  ds_read_b64_tr_b16 v[110:111], v15 offset:14848
  s_waitcnt lgkmcnt(4)
  v_mfma_f32_32x32x16_bf16 v[64:79], v[100:103], v[148:151], v[64:79]
  ds_read_b64_tr_b16 v[96:97], v15 offset:16384
  ds_read_b64_tr_b16 v[98:99], v15 offset:16896
  s_waitcnt lgkmcnt(4)
  v_mfma_f32_32x32x16_bf16 v[64:79], v[104:107], v[152:155], v[64:79]
  ds_read_b64_tr_b16 v[100:101], v15 offset:18432
  ds_read_b64_tr_b16 v[102:103], v15 offset:18944
  s_waitcnt lgkmcnt(4)
  v_mfma_f32_32x32x16_bf16 v[64:79], v[108:111], v[156:159], v[64:79]
  ds_read_b64_tr_b16 v[104:105], v15 offset:20480
  ds_read_b64_tr_b16 v[106:107], v15 offset:20992
  s_waitcnt lgkmcnt(4)
  v_mfma_f32_32x32x16_bf16 v[64:79], v[96:99], v[160:163], v[64:79]
  ds_read_b64_tr_b16 v[108:109], v15 offset:22528
  ds_read_b64_tr_b16 v[110:111], v15 offset:23040
  s_waitcnt lgkmcnt(4)
  v_mfma_f32_32x32x16_bf16 v[64:79], v[100:103], v[164:167], v[64:79]
  ds_read_b64_tr_b16 v[96:97], v15 offset:24576
  ds_read_b64_tr_b16 v[98:99], v15 offset:25088
  s_waitcnt lgkmcnt(4)
  v_mfma_f32_32x32x16_bf16 v[64:79], v[104:107], v[168:171], v[64:79]
  ds_read_b64_tr_b16 v[100:101], v15 offset:26624
  ds_read_b64_tr_b16 v[102:103], v15 offset:27136
  s_waitcnt lgkmcnt(4)
  v_mfma_f32_32x32x16_bf16 v[64:79], v[108:111], v[172:175], v[64:79]
  ds_read_b64_tr_b16 v[104:105], v15 offset:28672
  ds_read_b64_tr_b16 v[106:107], v15 offset:29184
  s_waitcnt lgkmcnt(4)
  v_mfma_f32_32x32x16_bf16 v[64:79], v[96:99], v[176:179], v[64:79]
  ds_read_b64_tr_b16 v[108:109], v15 offset:30720
  ds_read_b64_tr_b16 v[110:111], v15 offset:31232
  s_waitcnt lgkmcnt(4)
  v_mfma_f32_32x32x16_bf16 v[64:79], v[100:103], v[180:183], v[64:79]
  ds_read_b64_tr_b16 v[96:97], v15 offset:32768
  ds_read_b64_tr_b16 v[98:99], v15 offset:33280
  s_waitcnt lgkmcnt(4)
  v_mfma_f32_32x32x16_bf16 v[64:79], v[104:107], v[184:187], v[64:79]
  ds_read_b64_tr_b16 v[100:101], v15 offset:34816
  ds_read_b64_tr_b16 v[102:103], v15 offset:35328
  s_waitcnt lgkmcnt(4)
  v_mfma_f32_32x32x16_bf16 v[64:79], v[108:111], v[188:191], v[64:79]
  ds_read_b64_tr_b16 v[104:105], v15 offset:36864
  ds_read_b64_tr_b16 v[106:107], v15 offset:37376
  s_waitcnt lgkmcnt(4)
  v_mfma_f32_32x32x16_bf16 v[64:79], v[96:99], v[192:195], v[64:79]
  ds_read_b64_tr_b16 v[108:109], v15 offset:38912
  ds_read_b64_tr_b16 v[110:111], v15 offset:39424
  s_waitcnt lgkmcnt(4)
  v_mfma_f32_32x32x16_bf16 v[64:79], v[100:103], v[196:199], v[64:79]
  ds_read_b64_tr_b16 v[96:97], v15 offset:40960
  ds_read_b64_tr_b16 v[98:99], v15 offset:41472
  s_waitcnt lgkmcnt(4)
  v_mfma_f32_32x32x16_bf16 v[64:79], v[104:107], v[200:203], v[64:79]
  ds_read_b64_tr_b16 v[100:101], v15 offset:43008
  ds_read_b64_tr_b16 v[102:103], v15 offset:43520
  s_waitcnt lgkmcnt(4)
  v_mfma_f32_32x32x16_bf16 v[64:79], v[108:111], v[204:207], v[64:79]
  ds_read_b64_tr_b16 v[104:105], v15 offset:45056
  ds_read_b64_tr_b16 v[106:107], v15 offset:45568
  s_waitcnt lgkmcnt(4)
  v_mfma_f32_32x32x16_bf16 v[64:79], v[96:99], v[208:211], v[64:79]
  ds_read_b64_tr_b16 v[108:109], v15 offset:47104
  ds_read_b64_tr_b16 v[110:111], v15 offset:47616
  s_waitcnt lgkmcnt(4)
  v_mfma_f32_32x32x16_bf16 v[64:79], v[100:103], v[212:215], v[64:79]
  ds_read_b64_tr_b16 v[96:97], v15 offset:49152
  ds_read_b64_tr_b16 v[98:99], v15 offset:49664
  s_waitcnt lgkmcnt(4)
  v_mfma_f32_32x32x16_bf16 v[64:79], v[104:107], v[216:219], v[64:79]
  ds_read_b64_tr_b16 v[100:101], v15 offset:51200
  ds_read_b64_tr_b16 v[102:103], v15 offset:51712
  s_waitcnt lgkmcnt(4)
  v_mfma_f32_32x32x16_bf16 v[64:79], v[108:111], v[220:223], v[64:79]
  ds_read_b64_tr_b16 v[104:105], v15 offset:53248
  ds_read_b64_tr_b16 v[106:107], v15 offset:53760
  s_waitcnt lgkmcnt(4)
  v_mfma_f32_32x32x16_bf16 v[64:79], v[96:99], v[224:227], v[64:79]
  ds_read_b64_tr_b16 v[108:109], v15 offset:55296
  ds_read_b64_tr_b16 v[110:111], v15 offset:55808
  s_waitcnt lgkmcnt(4)
  v_mfma_f32_32x32x16_bf16 v[64:79], v[100:103], v[228:231], v[64:79]
  ds_read_b64_tr_b16 v[96:97], v15 offset:57344
  ds_read_b64_tr_b16 v[98:99], v15 offset:57856
  s_waitcnt lgkmcnt(4)
  v_mfma_f32_32x32x16_bf16 v[64:79], v[104:107], v[232:235], v[64:79]
  ds_read_b64_tr_b16 v[100:101], v15 offset:59392
  ds_read_b64_tr_b16 v[102:103], v15 offset:59904
  s_waitcnt lgkmcnt(4)
  v_mfma_f32_32x32x16_bf16 v[64:79], v[108:111], v[236:239], v[64:79]
  ds_read_b64_tr_b16 v[104:105], v15 offset:61440
  ds_read_b64_tr_b16 v[106:107], v15 offset:61952
  s_waitcnt lgkmcnt(4)
  v_mfma_f32_32x32x16_bf16 v[64:79], v[96:99], v[240:243], v[64:79]
  ds_read_b64_tr_b16 v[108:109], v15 offset:63488
  ds_read_b64_tr_b16 v[110:111], v15 offset:64000
  s_waitcnt lgkmcnt(4)
  v_mfma_f32_32x32x16_bf16 v[64:79], v[100:103], v[244:247], v[64:79]
  s_waitcnt lgkmcnt(2)
  v_mfma_f32_32x32x16_bf16 v[64:79], v[104:107], v[248:251], v[64:79]
  s_waitcnt lgkmcnt(0)
  v_mfma_f32_32x32x16_bf16 v[64:79], v[108:111], v[252:255], v[64:79]
  v_lshrrev_b32 v24, 5, v0
  v_lshlrev_b32 v24, 4, v24
  v_add_u32 v24, 133760, v24
  ds_read_b128 v[32:35], v24 offset:0
  ds_read_b128 v[36:39], v24 offset:32
  ds_read_b128 v[40:43], v24 offset:64
  ds_read_b128 v[44:47], v24 offset:96
  v_lshrrev_b32 v25, 5, v0
  v_lshlrev_b32 v25, 4, v25
  v_add_u32 v25, 134784, v25
  ds_read_b128 v[48:51], v25 offset:0
  ds_read_b128 v[52:55], v25 offset:32
  ds_read_b128 v[56:59], v25 offset:64
  ds_read_b128 v[60:63], v25 offset:96
  s_mul_i32 s73, s62, 144
  s_lshr_b32 s74, s83, 4
  s_add_u32 s73, s73, s74
  s_lshl_b32 s73, s73, 10
  s_add_u32 s73, s73, 10485760
  s_waitcnt lgkmcnt(0)
  v_fma_f32 v64, v32, v18, v64
  v_fma_f32 v65, v33, v18, v65
  v_fma_f32 v66, v34, v18, v66
  v_fma_f32 v67, v35, v18, v67
  v_fma_f32 v68, v36, v18, v68
  v_fma_f32 v69, v37, v18, v69
  v_fma_f32 v70, v38, v18, v70
  v_fma_f32 v71, v39, v18, v71
  v_fma_f32 v72, v40, v18, v72
  v_fma_f32 v73, v41, v18, v73
  v_fma_f32 v74, v42, v18, v74
  v_fma_f32 v75, v43, v18, v75
  v_fma_f32 v76, v44, v18, v76
  v_fma_f32 v77, v45, v18, v77
  v_fma_f32 v78, v46, v18, v78
  v_fma_f32 v79, v47, v18, v79
  v_fma_f32 v64, v64, v19, v48
  v_fma_f32 v65, v65, v19, v49
  v_fma_f32 v66, v66, v19, v50
  v_fma_f32 v67, v67, v19, v51
  v_fma_f32 v68, v68, v19, v52
  v_fma_f32 v69, v69, v19, v53
  v_fma_f32 v70, v70, v19, v54
  v_fma_f32 v71, v71, v19, v55
  v_fma_f32 v72, v72, v19, v56
  v_fma_f32 v73, v73, v19, v57
  v_fma_f32 v74, v74, v19, v58
  v_fma_f32 v75, v75, v19, v59
  v_fma_f32 v76, v76, v19, v60
  v_fma_f32 v77, v77, v19, v61
  v_fma_f32 v78, v78, v19, v62
  v_fma_f32 v79, v79, v19, v63
  v_mul_f32 v32, 0x3fb8aa3b, v64
  v_mul_f32 v33, 0x3fb8aa3b, v65
  v_mul_f32 v34, 0x3fb8aa3b, v66
  v_mul_f32 v35, 0x3fb8aa3b, v67
  v_mul_f32 v36, 0x3fb8aa3b, v68
  v_mul_f32 v37, 0x3fb8aa3b, v69
  v_mul_f32 v38, 0x3fb8aa3b, v70
  v_mul_f32 v39, 0x3fb8aa3b, v71
  v_mul_f32 v40, 0x3fb8aa3b, v72
  v_mul_f32 v41, 0x3fb8aa3b, v73
  v_mul_f32 v42, 0x3fb8aa3b, v74
  v_mul_f32 v43, 0x3fb8aa3b, v75
  v_mul_f32 v44, 0x3fb8aa3b, v76
  v_mul_f32 v45, 0x3fb8aa3b, v77
  v_mul_f32 v46, 0x3fb8aa3b, v78
  v_mul_f32 v47, 0x3fb8aa3b, v79
  v_exp_f32 v32, v32
  v_exp_f32 v33, v33
  v_exp_f32 v34, v34
  v_exp_f32 v35, v35
  v_exp_f32 v36, v36
  v_exp_f32 v37, v37
  v_exp_f32 v38, v38
  v_exp_f32 v39, v39
  v_exp_f32 v40, v40
  v_exp_f32 v41, v41
  v_exp_f32 v42, v42
  v_exp_f32 v43, v43
  v_exp_f32 v44, v44
  v_exp_f32 v45, v45
  v_exp_f32 v46, v46
  v_exp_f32 v47, v47
  v_fma_f32 v48, 0.5, v32, 1.0
  v_fma_f32 v49, 0.5, v33, 1.0
  v_fma_f32 v50, 0.5, v34, 1.0
  v_fma_f32 v51, 0.5, v35, 1.0
  v_fma_f32 v52, 0.5, v36, 1.0
  v_fma_f32 v53, 0.5, v37, 1.0
  v_fma_f32 v54, 0.5, v38, 1.0
  v_fma_f32 v55, 0.5, v39, 1.0
  v_fma_f32 v56, 0.5, v40, 1.0
  v_fma_f32 v57, 0.5, v41, 1.0
  v_fma_f32 v58, 0.5, v42, 1.0
  v_fma_f32 v59, 0.5, v43, 1.0
  v_fma_f32 v60, 0.5, v44, 1.0
  v_fma_f32 v61, 0.5, v45, 1.0
  v_fma_f32 v62, 0.5, v46, 1.0
  v_fma_f32 v63, 0.5, v47, 1.0
  v_fma_f32 v48, v48, v32, 1.0
  v_fma_f32 v49, v49, v33, 1.0
  v_fma_f32 v50, v50, v34, 1.0
  v_fma_f32 v51, v51, v35, 1.0
  v_fma_f32 v52, v52, v36, 1.0
  v_fma_f32 v53, v53, v37, 1.0
  v_fma_f32 v54, v54, v38, 1.0
  v_fma_f32 v55, v55, v39, 1.0
  v_fma_f32 v56, v56, v40, 1.0
  v_fma_f32 v57, v57, v41, 1.0
  v_fma_f32 v58, v58, v42, 1.0
  v_fma_f32 v59, v59, v43, 1.0
  v_fma_f32 v60, v60, v44, 1.0
  v_fma_f32 v61, v61, v45, 1.0
  v_fma_f32 v62, v62, v46, 1.0
  v_fma_f32 v63, v63, v47, 1.0
  v_rcp_f32 v48, v48
  v_rcp_f32 v49, v49
  v_rcp_f32 v50, v50
  v_rcp_f32 v51, v51
  v_rcp_f32 v52, v52
  v_rcp_f32 v53, v53
  v_rcp_f32 v54, v54
  v_rcp_f32 v55, v55
  v_rcp_f32 v56, v56
  v_rcp_f32 v57, v57
  v_rcp_f32 v58, v58
  v_rcp_f32 v59, v59
  v_rcp_f32 v60, v60
  v_rcp_f32 v61, v61
  v_rcp_f32 v62, v62
  v_rcp_f32 v63, v63
  s_nop 0
  v_fma_f32 v64, -v64, v48, v64
  v_fma_f32 v65, -v65, v49, v65
  v_fma_f32 v66, -v66, v50, v66
  v_fma_f32 v67, -v67, v51, v67
  v_fma_f32 v68, -v68, v52, v68
  v_fma_f32 v69, -v69, v53, v69
  v_fma_f32 v70, -v70, v54, v70
  v_fma_f32 v71, -v71, v55, v71
  v_fma_f32 v72, -v72, v56, v72
  v_fma_f32 v73, -v73, v57, v73
  v_fma_f32 v74, -v74, v58, v74
  v_fma_f32 v75, -v75, v59, v75
  v_fma_f32 v76, -v76, v60, v76
  v_fma_f32 v77, -v77, v61, v77
  v_fma_f32 v78, -v78, v62, v78
  v_fma_f32 v79, -v79, v63, v79
  v_cvt_pk_bf16_f32 v64, v64, v65
  v_cvt_pk_bf16_f32 v65, v66, v67
  v_cvt_pk_bf16_f32 v66, v68, v69
  v_cvt_pk_bf16_f32 v67, v70, v71
  v_cvt_pk_bf16_f32 v68, v72, v73
  v_cvt_pk_bf16_f32 v69, v74, v75
  v_cvt_pk_bf16_f32 v70, v76, v77
  v_cvt_pk_bf16_f32 v71, v78, v79
  buffer_store_dwordx4 v[64:67], v16, s[20:23], s73 offen sc1
  buffer_store_dwordx4 v[68:71], v16, s[20:23], s73 offen offset:1024 sc1
  s_waitcnt vmcnt(2)
  v_lshrrev_b32 v24, 5, v0
  v_lshlrev_b32 v24, 9, v24
  s_add_u32 s73, s64, 71936
  v_sub_u32 v24, s73, v24
  v_add_u32 v25, v24, v15
  v_add_u32 v24, v24, v14
  s_xor_b32 s74, s64, 8192
  s_sub_u32 s74, s74, s64
  v_add_u32 v26, s74, v24
  v_add_u32 v27, s74, v25
  ds_read_b64_tr_b16 v[48:49], v24
  ds_read_b64_tr_b16 v[50:51], v24 offset:1024
  ds_read_b64_tr_b16 v[52:53], v25
  ds_read_b64_tr_b16 v[54:55], v25 offset:1024
  ds_read_b64_tr_b16 v[56:57], v26
  ds_read_b64_tr_b16 v[58:59], v26 offset:1024
  ds_read_b64_tr_b16 v[60:61], v27
  ds_read_b64_tr_b16 v[62:63], v27 offset:1024
  s_add_u32 s73, s80, 147456
  s_add_u32 s74, s33, 147456
  s_waitcnt lgkmcnt(0)
  buffer_store_dwordx4 v[48:51], v16, s[20:23], s80 offen sc1
  buffer_store_dwordx4 v[52:55], v16, s[20:23], s73 offen sc1
  buffer_store_dwordx4 v[56:59], v16, s[20:23], s33 offen sc1
  buffer_store_dwordx4 v[60:63], v16, s[20:23], s74 offen sc1
  s_cmp_eq_u32 s57, 1
  s_cbranch_scc0 k1_f1d1
  s_and_b32 s73, s2, 31
  s_lshr_b32 s73, s73, 2
  s_lshl_b32 s73, s73, 7
  s_add_u32 s73, s73, 20975616
  v_and_b32 v24, 31, v0
  v_lshlrev_b32 v24, 2, v24
  s_mov_b32 s77, 0
k1_f1p1:
  buffer_load_dword v25, v24, s[20:23], s73 offen sc1
  s_waitcnt vmcnt(0)
  v_cmp_eq_u32 vcc, s90, v25
  s_add_u32 s77, s77, 1
  s_cmp_gt_u32 s77, 200000
  s_cbranch_scc1 k1_f1d1
  s_cmp_eq_u64 vcc, exec
  s_cbranch_scc0 k1_f1p1
k1_f1d1:
  s_waitcnt lgkmcnt(0)
  s_barrier
  s_branch k1_phase2
k1_YB:
  s_add_u32 s83, s81, 128
  s_lshr_b32 s83, s83, 1
  v_lshrrev_b32 v24, 5, v0
  v_lshlrev_b32 v24, 4, v24
  v_add_u32 v24, 133376, v24
  ds_read_b128 v[32:35], v24 offset:0
  ds_read_b128 v[36:39], v24 offset:32
  ds_read_b128 v[40:43], v24 offset:64
  ds_read_b128 v[44:47], v24 offset:96
  v_lshrrev_b32 v25, 5, v0
  v_lshlrev_b32 v25, 4, v25
  v_add_u32 v25, 134400, v25
  ds_read_b128 v[48:51], v25 offset:0
  ds_read_b128 v[52:55], v25 offset:32
  ds_read_b128 v[56:59], v25 offset:64
  ds_read_b128 v[60:63], v25 offset:96
  s_mul_i32 s73, s62, 144
  s_lshr_b32 s74, s83, 4
  s_add_u32 s73, s73, s74
  s_lshl_b32 s73, s73, 10
  s_add_u32 s73, s73, 10485760
  s_waitcnt lgkmcnt(0)
  v_mov_b32 v26, 0x3fb8aa3b
  v_mov_b32 v28, 0.5
  v_mov_b32 v30, 1.0
  v_pk_fma_f32 v[64:65], v[32:33], v[18:19], v[64:65] op_sel_hi:[1,0,1]
  v_pk_fma_f32 v[66:67], v[34:35], v[18:19], v[66:67] op_sel_hi:[1,0,1]
  v_pk_fma_f32 v[68:69], v[36:37], v[18:19], v[68:69] op_sel_hi:[1,0,1]
  v_pk_fma_f32 v[70:71], v[38:39], v[18:19], v[70:71] op_sel_hi:[1,0,1]
  v_pk_fma_f32 v[72:73], v[40:41], v[18:19], v[72:73] op_sel_hi:[1,0,1]
  v_pk_fma_f32 v[74:75], v[42:43], v[18:19], v[74:75] op_sel_hi:[1,0,1]
  v_pk_fma_f32 v[76:77], v[44:45], v[18:19], v[76:77] op_sel_hi:[1,0,1]
  v_pk_fma_f32 v[78:79], v[46:47], v[18:19], v[78:79] op_sel_hi:[1,0,1]
  v_pk_fma_f32 v[64:65], v[64:65], v[18:19], v[48:49] op_sel:[0,1,0] op_sel_hi:[1,1,1]
  v_pk_fma_f32 v[66:67], v[66:67], v[18:19], v[50:51] op_sel:[0,1,0] op_sel_hi:[1,1,1]
  v_pk_fma_f32 v[68:69], v[68:69], v[18:19], v[52:53] op_sel:[0,1,0] op_sel_hi:[1,1,1]
  v_pk_fma_f32 v[70:71], v[70:71], v[18:19], v[54:55] op_sel:[0,1,0] op_sel_hi:[1,1,1]
  v_pk_fma_f32 v[72:73], v[72:73], v[18:19], v[56:57] op_sel:[0,1,0] op_sel_hi:[1,1,1]
  v_pk_fma_f32 v[74:75], v[74:75], v[18:19], v[58:59] op_sel:[0,1,0] op_sel_hi:[1,1,1]
  v_pk_fma_f32 v[76:77], v[76:77], v[18:19], v[60:61] op_sel:[0,1,0] op_sel_hi:[1,1,1]
  v_pk_fma_f32 v[78:79], v[78:79], v[18:19], v[62:63] op_sel:[0,1,0] op_sel_hi:[1,1,1]
  v_pk_mul_f32 v[32:33], v[64:65], v[26:27] op_sel_hi:[1,0]
  v_pk_mul_f32 v[34:35], v[66:67], v[26:27] op_sel_hi:[1,0]
  v_pk_mul_f32 v[36:37], v[68:69], v[26:27] op_sel_hi:[1,0]
  v_pk_mul_f32 v[38:39], v[70:71], v[26:27] op_sel_hi:[1,0]
  v_pk_mul_f32 v[40:41], v[72:73], v[26:27] op_sel_hi:[1,0]
  v_pk_mul_f32 v[42:43], v[74:75], v[26:27] op_sel_hi:[1,0]
  v_pk_mul_f32 v[44:45], v[76:77], v[26:27] op_sel_hi:[1,0]
  v_pk_mul_f32 v[46:47], v[78:79], v[26:27] op_sel_hi:[1,0]
  v_exp_f32 v32, v32
  v_exp_f32 v33, v33
  v_exp_f32 v34, v34
  v_exp_f32 v35, v35
  v_exp_f32 v36, v36
  v_exp_f32 v37, v37
  v_exp_f32 v38, v38
  v_exp_f32 v39, v39
  v_exp_f32 v40, v40
  v_exp_f32 v41, v41
  v_exp_f32 v42, v42
  v_exp_f32 v43, v43
  v_exp_f32 v44, v44
  v_exp_f32 v45, v45
  v_exp_f32 v46, v46
  v_exp_f32 v47, v47
  v_pk_fma_f32 v[48:49], v[32:33], v[28:29], v[30:31] op_sel_hi:[1,0,0]
  v_pk_fma_f32 v[50:51], v[34:35], v[28:29], v[30:31] op_sel_hi:[1,0,0]
  v_pk_fma_f32 v[52:53], v[36:37], v[28:29], v[30:31] op_sel_hi:[1,0,0]
  v_pk_fma_f32 v[54:55], v[38:39], v[28:29], v[30:31] op_sel_hi:[1,0,0]
  v_pk_fma_f32 v[56:57], v[40:41], v[28:29], v[30:31] op_sel_hi:[1,0,0]
  v_pk_fma_f32 v[58:59], v[42:43], v[28:29], v[30:31] op_sel_hi:[1,0,0]
  v_pk_fma_f32 v[60:61], v[44:45], v[28:29], v[30:31] op_sel_hi:[1,0,0]
  v_pk_fma_f32 v[62:63], v[46:47], v[28:29], v[30:31] op_sel_hi:[1,0,0]
  v_pk_fma_f32 v[48:49], v[48:49], v[32:33], v[30:31] op_sel_hi:[1,1,0]
  v_pk_fma_f32 v[50:51], v[50:51], v[34:35], v[30:31] op_sel_hi:[1,1,0]
  v_pk_fma_f32 v[52:53], v[52:53], v[36:37], v[30:31] op_sel_hi:[1,1,0]
  v_pk_fma_f32 v[54:55], v[54:55], v[38:39], v[30:31] op_sel_hi:[1,1,0]
  v_pk_fma_f32 v[56:57], v[56:57], v[40:41], v[30:31] op_sel_hi:[1,1,0]
  v_pk_fma_f32 v[58:59], v[58:59], v[42:43], v[30:31] op_sel_hi:[1,1,0]
  v_pk_fma_f32 v[60:61], v[60:61], v[44:45], v[30:31] op_sel_hi:[1,1,0]
  v_pk_fma_f32 v[62:63], v[62:63], v[46:47], v[30:31] op_sel_hi:[1,1,0]
  v_rcp_f32 v48, v48
  v_rcp_f32 v49, v49
  v_rcp_f32 v50, v50
  v_rcp_f32 v51, v51
  v_rcp_f32 v52, v52
  v_rcp_f32 v53, v53
  v_rcp_f32 v54, v54
  v_rcp_f32 v55, v55
  v_rcp_f32 v56, v56
  v_rcp_f32 v57, v57
  v_rcp_f32 v58, v58
  v_rcp_f32 v59, v59
  v_rcp_f32 v60, v60
  v_rcp_f32 v61, v61
  v_rcp_f32 v62, v62
  v_rcp_f32 v63, v63
  s_nop 0
  v_pk_fma_f32 v[64:65], v[64:65], v[48:49], v[64:65] neg_lo:[1,0,0] neg_hi:[1,0,0]
  v_pk_fma_f32 v[66:67], v[66:67], v[50:51], v[66:67] neg_lo:[1,0,0] neg_hi:[1,0,0]
  v_pk_fma_f32 v[68:69], v[68:69], v[52:53], v[68:69] neg_lo:[1,0,0] neg_hi:[1,0,0]
  v_pk_fma_f32 v[70:71], v[70:71], v[54:55], v[70:71] neg_lo:[1,0,0] neg_hi:[1,0,0]
  v_pk_fma_f32 v[72:73], v[72:73], v[56:57], v[72:73] neg_lo:[1,0,0] neg_hi:[1,0,0]
  v_pk_fma_f32 v[74:75], v[74:75], v[58:59], v[74:75] neg_lo:[1,0,0] neg_hi:[1,0,0]
  v_pk_fma_f32 v[76:77], v[76:77], v[60:61], v[76:77] neg_lo:[1,0,0] neg_hi:[1,0,0]
  v_pk_fma_f32 v[78:79], v[78:79], v[62:63], v[78:79] neg_lo:[1,0,0] neg_hi:[1,0,0]
  v_cvt_pk_bf16_f32 v64, v64, v65
  v_cvt_pk_bf16_f32 v65, v66, v67
  v_cvt_pk_bf16_f32 v66, v68, v69
  v_cvt_pk_bf16_f32 v67, v70, v71
  v_cvt_pk_bf16_f32 v68, v72, v73
  v_cvt_pk_bf16_f32 v69, v74, v75
  v_cvt_pk_bf16_f32 v70, v76, v77
  v_cvt_pk_bf16_f32 v71, v78, v79
  buffer_store_dwordx4 v[64:67], v16, s[20:23], s73 offen sc1
  buffer_store_dwordx4 v[68:71], v16, s[20:23], s73 offen offset:1024 sc1
  s_waitcnt vmcnt(2)
  s_barrier
  s_add_u32 s83, s81, 192
  s_lshr_b32 s83, s83, 1
  v_lshrrev_b32 v24, 5, v0
  v_lshlrev_b32 v24, 4, v24
  v_add_u32 v24, 133504, v24
  ds_read_b128 v[32:35], v24 offset:0
  ds_read_b128 v[36:39], v24 offset:32
  ds_read_b128 v[40:43], v24 offset:64
  ds_read_b128 v[44:47], v24 offset:96
  v_lshrrev_b32 v25, 5, v0
  v_lshlrev_b32 v25, 4, v25
  v_add_u32 v25, 134528, v25
  ds_read_b128 v[48:51], v25 offset:0
  ds_read_b128 v[52:55], v25 offset:32
  ds_read_b128 v[56:59], v25 offset:64
  ds_read_b128 v[60:63], v25 offset:96
  s_mul_i32 s73, s62, 144
  s_lshr_b32 s74, s83, 4
  s_add_u32 s73, s73, s74
  s_lshl_b32 s73, s73, 10
  s_add_u32 s73, s73, 10485760
  s_waitcnt lgkmcnt(0)
  v_fma_f32 v80, v32, v18, v80
  v_fma_f32 v81, v33, v18, v81
  v_fma_f32 v82, v34, v18, v82
  v_fma_f32 v83, v35, v18, v83
  v_fma_f32 v84, v36, v18, v84
  v_fma_f32 v85, v37, v18, v85
  v_fma_f32 v86, v38, v18, v86
  v_fma_f32 v87, v39, v18, v87
  v_fma_f32 v88, v40, v18, v88
  v_fma_f32 v89, v41, v18, v89
  v_fma_f32 v90, v42, v18, v90
  v_fma_f32 v91, v43, v18, v91
  v_fma_f32 v92, v44, v18, v92
  v_fma_f32 v93, v45, v18, v93
  v_fma_f32 v94, v46, v18, v94
  v_fma_f32 v95, v47, v18, v95
  v_fma_f32 v80, v80, v19, v48
  v_fma_f32 v81, v81, v19, v49
  v_fma_f32 v82, v82, v19, v50
  v_fma_f32 v83, v83, v19, v51
  v_fma_f32 v84, v84, v19, v52
  v_fma_f32 v85, v85, v19, v53
  v_fma_f32 v86, v86, v19, v54
  v_fma_f32 v87, v87, v19, v55
  v_fma_f32 v88, v88, v19, v56
  v_fma_f32 v89, v89, v19, v57
  v_fma_f32 v90, v90, v19, v58
  v_fma_f32 v91, v91, v19, v59
  v_fma_f32 v92, v92, v19, v60
  v_fma_f32 v93, v93, v19, v61
  v_fma_f32 v94, v94, v19, v62
  v_fma_f32 v95, v95, v19, v63
  v_mul_f32 v32, 0x3fb8aa3b, v80
  v_mul_f32 v33, 0x3fb8aa3b, v81
  v_mul_f32 v34, 0x3fb8aa3b, v82
  v_mul_f32 v35, 0x3fb8aa3b, v83
  v_mul_f32 v36, 0x3fb8aa3b, v84
  v_mul_f32 v37, 0x3fb8aa3b, v85
  v_mul_f32 v38, 0x3fb8aa3b, v86
  v_mul_f32 v39, 0x3fb8aa3b, v87
  v_mul_f32 v40, 0x3fb8aa3b, v88
  v_mul_f32 v41, 0x3fb8aa3b, v89
  v_mul_f32 v42, 0x3fb8aa3b, v90
  v_mul_f32 v43, 0x3fb8aa3b, v91
  v_mul_f32 v44, 0x3fb8aa3b, v92
  v_mul_f32 v45, 0x3fb8aa3b, v93
  v_mul_f32 v46, 0x3fb8aa3b, v94
  v_mul_f32 v47, 0x3fb8aa3b, v95
  v_exp_f32 v32, v32
  v_exp_f32 v33, v33
  v_exp_f32 v34, v34
  v_exp_f32 v35, v35
  v_exp_f32 v36, v36
  v_exp_f32 v37, v37
  v_exp_f32 v38, v38
  v_exp_f32 v39, v39
  v_exp_f32 v40, v40
  v_exp_f32 v41, v41
  v_exp_f32 v42, v42
  v_exp_f32 v43, v43
  v_exp_f32 v44, v44
  v_exp_f32 v45, v45
  v_exp_f32 v46, v46
  v_exp_f32 v47, v47
  v_fma_f32 v48, 0.5, v32, 1.0
  v_fma_f32 v49, 0.5, v33, 1.0
  v_fma_f32 v50, 0.5, v34, 1.0
  v_fma_f32 v51, 0.5, v35, 1.0
  v_fma_f32 v52, 0.5, v36, 1.0
  v_fma_f32 v53, 0.5, v37, 1.0
  v_fma_f32 v54, 0.5, v38, 1.0
  v_fma_f32 v55, 0.5, v39, 1.0
  v_fma_f32 v56, 0.5, v40, 1.0
  v_fma_f32 v57, 0.5, v41, 1.0
  v_fma_f32 v58, 0.5, v42, 1.0
  v_fma_f32 v59, 0.5, v43, 1.0
  v_fma_f32 v60, 0.5, v44, 1.0
  v_fma_f32 v61, 0.5, v45, 1.0
  v_fma_f32 v62, 0.5, v46, 1.0
  v_fma_f32 v63, 0.5, v47, 1.0
  v_fma_f32 v48, v48, v32, 1.0
  v_fma_f32 v49, v49, v33, 1.0
  v_fma_f32 v50, v50, v34, 1.0
  v_fma_f32 v51, v51, v35, 1.0
  v_fma_f32 v52, v52, v36, 1.0
  v_fma_f32 v53, v53, v37, 1.0
  v_fma_f32 v54, v54, v38, 1.0
  v_fma_f32 v55, v55, v39, 1.0
  v_fma_f32 v56, v56, v40, 1.0
  v_fma_f32 v57, v57, v41, 1.0
  v_fma_f32 v58, v58, v42, 1.0
  v_fma_f32 v59, v59, v43, 1.0
  v_fma_f32 v60, v60, v44, 1.0
  v_fma_f32 v61, v61, v45, 1.0
  v_fma_f32 v62, v62, v46, 1.0
  v_fma_f32 v63, v63, v47, 1.0
  v_rcp_f32 v48, v48
  v_rcp_f32 v49, v49
  v_rcp_f32 v50, v50
  v_rcp_f32 v51, v51
  v_rcp_f32 v52, v52
  v_rcp_f32 v53, v53
  v_rcp_f32 v54, v54
  v_rcp_f32 v55, v55
  v_rcp_f32 v56, v56
  v_rcp_f32 v57, v57
  v_rcp_f32 v58, v58
  v_rcp_f32 v59, v59
  v_rcp_f32 v60, v60
  v_rcp_f32 v61, v61
  v_rcp_f32 v62, v62
  v_rcp_f32 v63, v63
  s_nop 0
  v_fma_f32 v80, -v80, v48, v80
  v_fma_f32 v81, -v81, v49, v81
  v_fma_f32 v82, -v82, v50, v82
  v_fma_f32 v83, -v83, v51, v83
  v_fma_f32 v84, -v84, v52, v84
  v_fma_f32 v85, -v85, v53, v85
  v_fma_f32 v86, -v86, v54, v86
  v_fma_f32 v87, -v87, v55, v87
  v_fma_f32 v88, -v88, v56, v88
  v_fma_f32 v89, -v89, v57, v89
  v_fma_f32 v90, -v90, v58, v90
  v_fma_f32 v91, -v91, v59, v91
  v_fma_f32 v92, -v92, v60, v92
  v_fma_f32 v93, -v93, v61, v93
  v_fma_f32 v94, -v94, v62, v94
  v_fma_f32 v95, -v95, v63, v95
  v_cvt_pk_bf16_f32 v80, v80, v81
  v_cvt_pk_bf16_f32 v81, v82, v83
  v_cvt_pk_bf16_f32 v82, v84, v85
  v_cvt_pk_bf16_f32 v83, v86, v87
  v_cvt_pk_bf16_f32 v84, v88, v89
  v_cvt_pk_bf16_f32 v85, v90, v91
  v_cvt_pk_bf16_f32 v86, v92, v93
  v_cvt_pk_bf16_f32 v87, v94, v95
  buffer_store_dwordx4 v[80:83], v16, s[20:23], s73 offen sc1
  buffer_store_dwordx4 v[84:87], v16, s[20:23], s73 offen offset:1024 sc1
  s_add_u32 s83, s81, 320
  s_lshr_b32 s83, s83, 1
  ds_read_b64_tr_b16 v[96:97], v15 offset:0
  ds_read_b64_tr_b16 v[98:99], v15 offset:512
  ds_read_b64_tr_b16 v[100:101], v15 offset:2048
  ds_read_b64_tr_b16 v[102:103], v15 offset:2560
  ds_read_b64_tr_b16 v[104:105], v15 offset:4096
  ds_read_b64_tr_b16 v[106:107], v15 offset:4608
  s_waitcnt lgkmcnt(4)
  v_mfma_f32_32x32x16_bf16 v[64:79], v[96:99], v[128:131], 0
  ds_read_b64_tr_b16 v[108:109], v15 offset:6144
  ds_read_b64_tr_b16 v[110:111], v15 offset:6656
  s_waitcnt lgkmcnt(4)
  v_mfma_f32_32x32x16_bf16 v[64:79], v[100:103], v[132:135], v[64:79]
  ds_read_b64_tr_b16 v[96:97], v15 offset:8192
  ds_read_b64_tr_b16 v[98:99], v15 offset:8704
  s_waitcnt lgkmcnt(4)
  v_mfma_f32_32x32x16_bf16 v[64:79], v[104:107], v[136:139], v[64:79]
  ds_read_b64_tr_b16 v[100:101], v15 offset:10240
  ds_read_b64_tr_b16 v[102:103], v15 offset:10752
  s_waitcnt lgkmcnt(4)
  v_mfma_f32_32x32x16_bf16 v[64:79], v[108:111], v[140:143], v[64:79]
  ds_read_b64_tr_b16 v[104:105], v15 offset:12288
  ds_read_b64_tr_b16 v[106:107], v15 offset:12800
  s_waitcnt lgkmcnt(4)
  v_mfma_f32_32x32x16_bf16 v[64:79], v[96:99], v[144:147], v[64:79]
  ds_read_b64_tr_b16 v[108:109], v15 offset:14336
  ds_read_b64_tr_b16 v[110:111], v15 offset:14848
  s_waitcnt lgkmcnt(4)
  v_mfma_f32_32x32x16_bf16 v[64:79], v[100:103], v[148:151], v[64:79]
  ds_read_b64_tr_b16 v[96:97], v15 offset:16384
  ds_read_b64_tr_b16 v[98:99], v15 offset:16896
  s_waitcnt lgkmcnt(4)
  v_mfma_f32_32x32x16_bf16 v[64:79], v[104:107], v[152:155], v[64:79]
  ds_read_b64_tr_b16 v[100:101], v15 offset:18432
  ds_read_b64_tr_b16 v[102:103], v15 offset:18944
  s_waitcnt lgkmcnt(4)
  v_mfma_f32_32x32x16_bf16 v[64:79], v[108:111], v[156:159], v[64:79]
  ds_read_b64_tr_b16 v[104:105], v15 offset:20480
  ds_read_b64_tr_b16 v[106:107], v15 offset:20992
  s_waitcnt lgkmcnt(4)
  v_mfma_f32_32x32x16_bf16 v[64:79], v[96:99], v[160:163], v[64:79]
  ds_read_b64_tr_b16 v[108:109], v15 offset:22528
  ds_read_b64_tr_b16 v[110:111], v15 offset:23040
  s_waitcnt lgkmcnt(4)
  v_mfma_f32_32x32x16_bf16 v[64:79], v[100:103], v[164:167], v[64:79]
  ds_read_b64_tr_b16 v[96:97], v15 offset:24576
  ds_read_b64_tr_b16 v[98:99], v15 offset:25088
  s_waitcnt lgkmcnt(4)
  v_mfma_f32_32x32x16_bf16 v[64:79], v[104:107], v[168:171], v[64:79]
  ds_read_b64_tr_b16 v[100:101], v15 offset:26624
  ds_read_b64_tr_b16 v[102:103], v15 offset:27136
  s_waitcnt lgkmcnt(4)
  v_mfma_f32_32x32x16_bf16 v[64:79], v[108:111], v[172:175], v[64:79]
  ds_read_b64_tr_b16 v[104:105], v15 offset:28672
  ds_read_b64_tr_b16 v[106:107], v15 offset:29184
  s_waitcnt lgkmcnt(4)
  v_mfma_f32_32x32x16_bf16 v[64:79], v[96:99], v[176:179], v[64:79]
  ds_read_b64_tr_b16 v[108:109], v15 offset:30720
  ds_read_b64_tr_b16 v[110:111], v15 offset:31232
  s_waitcnt lgkmcnt(4)
  v_mfma_f32_32x32x16_bf16 v[64:79], v[100:103], v[180:183], v[64:79]
  ds_read_b64_tr_b16 v[96:97], v15 offset:32768
  ds_read_b64_tr_b16 v[98:99], v15 offset:33280
  s_waitcnt lgkmcnt(4)
  v_mfma_f32_32x32x16_bf16 v[64:79], v[104:107], v[184:187], v[64:79]
  ds_read_b64_tr_b16 v[100:101], v15 offset:34816
  ds_read_b64_tr_b16 v[102:103], v15 offset:35328
  s_waitcnt lgkmcnt(4)
  v_mfma_f32_32x32x16_bf16 v[64:79], v[108:111], v[188:191], v[64:79]
  ds_read_b64_tr_b16 v[104:105], v15 offset:36864
  ds_read_b64_tr_b16 v[106:107], v15 offset:37376
  s_waitcnt lgkmcnt(4)
  v_mfma_f32_32x32x16_bf16 v[64:79], v[96:99], v[192:195], v[64:79]
  ds_read_b64_tr_b16 v[108:109], v15 offset:38912
  ds_read_b64_tr_b16 v[110:111], v15 offset:39424
  s_waitcnt lgkmcnt(4)
  v_mfma_f32_32x32x16_bf16 v[64:79], v[100:103], v[196:199], v[64:79]
  ds_read_b64_tr_b16 v[96:97], v15 offset:40960
  ds_read_b64_tr_b16 v[98:99], v15 offset:41472
  s_waitcnt lgkmcnt(4)
  v_mfma_f32_32x32x16_bf16 v[64:79], v[104:107], v[200:203], v[64:79]
  ds_read_b64_tr_b16 v[100:101], v15 offset:43008
  ds_read_b64_tr_b16 v[102:103], v15 offset:43520
  s_waitcnt lgkmcnt(4)
  v_mfma_f32_32x32x16_bf16 v[64:79], v[108:111], v[204:207], v[64:79]
  ds_read_b64_tr_b16 v[104:105], v15 offset:45056
  ds_read_b64_tr_b16 v[106:107], v15 offset:45568
  s_waitcnt lgkmcnt(4)
  v_mfma_f32_32x32x16_bf16 v[64:79], v[96:99], v[208:211], v[64:79]
  ds_read_b64_tr_b16 v[108:109], v15 offset:47104
  ds_read_b64_tr_b16 v[110:111], v15 offset:47616
  s_waitcnt lgkmcnt(4)
  v_mfma_f32_32x32x16_bf16 v[64:79], v[100:103], v[212:215], v[64:79]
  ds_read_b64_tr_b16 v[96:97], v15 offset:49152
  ds_read_b64_tr_b16 v[98:99], v15 offset:49664
  s_waitcnt lgkmcnt(4)
  v_mfma_f32_32x32x16_bf16 v[64:79], v[104:107], v[216:219], v[64:79]
  ds_read_b64_tr_b16 v[100:101], v15 offset:51200
  ds_read_b64_tr_b16 v[102:103], v15 offset:51712
  s_waitcnt lgkmcnt(4)
  v_mfma_f32_32x32x16_bf16 v[64:79], v[108:111], v[220:223], v[64:79]
  ds_read_b64_tr_b16 v[104:105], v15 offset:53248
  ds_read_b64_tr_b16 v[106:107], v15 offset:53760
  s_waitcnt lgkmcnt(4)
  v_mfma_f32_32x32x16_bf16 v[64:79], v[96:99], v[224:227], v[64:79]
  ds_read_b64_tr_b16 v[108:109], v15 offset:55296
  ds_read_b64_tr_b16 v[110:111], v15 offset:55808
  s_waitcnt lgkmcnt(4)
  v_mfma_f32_32x32x16_bf16 v[64:79], v[100:103], v[228:231], v[64:79]
  ds_read_b64_tr_b16 v[96:97], v15 offset:57344
  ds_read_b64_tr_b16 v[98:99], v15 offset:57856
  s_waitcnt lgkmcnt(4)
  v_mfma_f32_32x32x16_bf16 v[64:79], v[104:107], v[232:235], v[64:79]
  ds_read_b64_tr_b16 v[100:101], v15 offset:59392
  ds_read_b64_tr_b16 v[102:103], v15 offset:59904
  s_waitcnt lgkmcnt(4)
  v_mfma_f32_32x32x16_bf16 v[64:79], v[108:111], v[236:239], v[64:79]
  ds_read_b64_tr_b16 v[104:105], v15 offset:61440
  ds_read_b64_tr_b16 v[106:107], v15 offset:61952
  s_waitcnt lgkmcnt(4)
  v_mfma_f32_32x32x16_bf16 v[64:79], v[96:99], v[240:243], v[64:79]
  ds_read_b64_tr_b16 v[108:109], v15 offset:63488
  ds_read_b64_tr_b16 v[110:111], v15 offset:64000
  s_waitcnt lgkmcnt(4)
  v_mfma_f32_32x32x16_bf16 v[64:79], v[100:103], v[244:247], v[64:79]
  s_waitcnt lgkmcnt(2)
  v_mfma_f32_32x32x16_bf16 v[64:79], v[104:107], v[248:251], v[64:79]
  s_waitcnt lgkmcnt(0)
  v_mfma_f32_32x32x16_bf16 v[64:79], v[108:111], v[252:255], v[64:79]
  v_lshrrev_b32 v24, 5, v0
  v_lshlrev_b32 v24, 4, v24
  v_add_u32 v24, 133760, v24
  ds_read_b128 v[32:35], v24 offset:0
  ds_read_b128 v[36:39], v24 offset:32
  ds_read_b128 v[40:43], v24 offset:64
  ds_read_b128 v[44:47], v24 offset:96
  v_lshrrev_b32 v25, 5, v0
  v_lshlrev_b32 v25, 4, v25
  v_add_u32 v25, 134784, v25
  ds_read_b128 v[48:51], v25 offset:0
  ds_read_b128 v[52:55], v25 offset:32
  ds_read_b128 v[56:59], v25 offset:64
  ds_read_b128 v[60:63], v25 offset:96
  s_mul_i32 s73, s62, 144
  s_lshr_b32 s74, s83, 4
  s_add_u32 s73, s73, s74
  s_lshl_b32 s73, s73, 10
  s_add_u32 s73, s73, 10485760
  s_waitcnt lgkmcnt(0)
  v_mov_b32 v26, 0x3fb8aa3b
  v_mov_b32 v28, 0.5
  v_mov_b32 v30, 1.0
  v_pk_fma_f32 v[64:65], v[32:33], v[18:19], v[64:65] op_sel_hi:[1,0,1]
  v_pk_fma_f32 v[66:67], v[34:35], v[18:19], v[66:67] op_sel_hi:[1,0,1]
  v_pk_fma_f32 v[68:69], v[36:37], v[18:19], v[68:69] op_sel_hi:[1,0,1]
  v_pk_fma_f32 v[70:71], v[38:39], v[18:19], v[70:71] op_sel_hi:[1,0,1]
  v_pk_fma_f32 v[72:73], v[40:41], v[18:19], v[72:73] op_sel_hi:[1,0,1]
  v_pk_fma_f32 v[74:75], v[42:43], v[18:19], v[74:75] op_sel_hi:[1,0,1]
  v_pk_fma_f32 v[76:77], v[44:45], v[18:19], v[76:77] op_sel_hi:[1,0,1]
  v_pk_fma_f32 v[78:79], v[46:47], v[18:19], v[78:79] op_sel_hi:[1,0,1]
  v_pk_fma_f32 v[64:65], v[64:65], v[18:19], v[48:49] op_sel:[0,1,0] op_sel_hi:[1,1,1]
  v_pk_fma_f32 v[66:67], v[66:67], v[18:19], v[50:51] op_sel:[0,1,0] op_sel_hi:[1,1,1]
  v_pk_fma_f32 v[68:69], v[68:69], v[18:19], v[52:53] op_sel:[0,1,0] op_sel_hi:[1,1,1]
  v_pk_fma_f32 v[70:71], v[70:71], v[18:19], v[54:55] op_sel:[0,1,0] op_sel_hi:[1,1,1]
  v_pk_fma_f32 v[72:73], v[72:73], v[18:19], v[56:57] op_sel:[0,1,0] op_sel_hi:[1,1,1]
  v_pk_fma_f32 v[74:75], v[74:75], v[18:19], v[58:59] op_sel:[0,1,0] op_sel_hi:[1,1,1]
  v_pk_fma_f32 v[76:77], v[76:77], v[18:19], v[60:61] op_sel:[0,1,0] op_sel_hi:[1,1,1]
  v_pk_fma_f32 v[78:79], v[78:79], v[18:19], v[62:63] op_sel:[0,1,0] op_sel_hi:[1,1,1]
  v_pk_mul_f32 v[32:33], v[64:65], v[26:27] op_sel_hi:[1,0]
  v_pk_mul_f32 v[34:35], v[66:67], v[26:27] op_sel_hi:[1,0]
  v_pk_mul_f32 v[36:37], v[68:69], v[26:27] op_sel_hi:[1,0]
  v_pk_mul_f32 v[38:39], v[70:71], v[26:27] op_sel_hi:[1,0]
  v_pk_mul_f32 v[40:41], v[72:73], v[26:27] op_sel_hi:[1,0]
  v_pk_mul_f32 v[42:43], v[74:75], v[26:27] op_sel_hi:[1,0]
  v_pk_mul_f32 v[44:45], v[76:77], v[26:27] op_sel_hi:[1,0]
  v_pk_mul_f32 v[46:47], v[78:79], v[26:27] op_sel_hi:[1,0]
  v_exp_f32 v32, v32
  v_exp_f32 v33, v33
  v_exp_f32 v34, v34
  v_exp_f32 v35, v35
  v_exp_f32 v36, v36
  v_exp_f32 v37, v37
  v_exp_f32 v38, v38
  v_exp_f32 v39, v39
  v_exp_f32 v40, v40
  v_exp_f32 v41, v41
  v_exp_f32 v42, v42
  v_exp_f32 v43, v43
  v_exp_f32 v44, v44
  v_exp_f32 v45, v45
  v_exp_f32 v46, v46
  v_exp_f32 v47, v47
  v_pk_fma_f32 v[48:49], v[32:33], v[28:29], v[30:31] op_sel_hi:[1,0,0]
  v_pk_fma_f32 v[50:51], v[34:35], v[28:29], v[30:31] op_sel_hi:[1,0,0]
  v_pk_fma_f32 v[52:53], v[36:37], v[28:29], v[30:31] op_sel_hi:[1,0,0]
  v_pk_fma_f32 v[54:55], v[38:39], v[28:29], v[30:31] op_sel_hi:[1,0,0]
  v_pk_fma_f32 v[56:57], v[40:41], v[28:29], v[30:31] op_sel_hi:[1,0,0]
  v_pk_fma_f32 v[58:59], v[42:43], v[28:29], v[30:31] op_sel_hi:[1,0,0]
  v_pk_fma_f32 v[60:61], v[44:45], v[28:29], v[30:31] op_sel_hi:[1,0,0]
  v_pk_fma_f32 v[62:63], v[46:47], v[28:29], v[30:31] op_sel_hi:[1,0,0]
  v_pk_fma_f32 v[48:49], v[48:49], v[32:33], v[30:31] op_sel_hi:[1,1,0]
  v_pk_fma_f32 v[50:51], v[50:51], v[34:35], v[30:31] op_sel_hi:[1,1,0]
  v_pk_fma_f32 v[52:53], v[52:53], v[36:37], v[30:31] op_sel_hi:[1,1,0]
  v_pk_fma_f32 v[54:55], v[54:55], v[38:39], v[30:31] op_sel_hi:[1,1,0]
  v_pk_fma_f32 v[56:57], v[56:57], v[40:41], v[30:31] op_sel_hi:[1,1,0]
  v_pk_fma_f32 v[58:59], v[58:59], v[42:43], v[30:31] op_sel_hi:[1,1,0]
  v_pk_fma_f32 v[60:61], v[60:61], v[44:45], v[30:31] op_sel_hi:[1,1,0]
  v_pk_fma_f32 v[62:63], v[62:63], v[46:47], v[30:31] op_sel_hi:[1,1,0]
  v_rcp_f32 v48, v48
  v_rcp_f32 v49, v49
  v_rcp_f32 v50, v50
  v_rcp_f32 v51, v51
  v_rcp_f32 v52, v52
  v_rcp_f32 v53, v53
  v_rcp_f32 v54, v54
  v_rcp_f32 v55, v55
  v_rcp_f32 v56, v56
  v_rcp_f32 v57, v57
  v_rcp_f32 v58, v58
  v_rcp_f32 v59, v59
  v_rcp_f32 v60, v60
  v_rcp_f32 v61, v61
  v_rcp_f32 v62, v62
  v_rcp_f32 v63, v63
  s_nop 0
  v_pk_fma_f32 v[64:65], v[64:65], v[48:49], v[64:65] neg_lo:[1,0,0] neg_hi:[1,0,0]
  v_pk_fma_f32 v[66:67], v[66:67], v[50:51], v[66:67] neg_lo:[1,0,0] neg_hi:[1,0,0]
  v_pk_fma_f32 v[68:69], v[68:69], v[52:53], v[68:69] neg_lo:[1,0,0] neg_hi:[1,0,0]
  v_pk_fma_f32 v[70:71], v[70:71], v[54:55], v[70:71] neg_lo:[1,0,0] neg_hi:[1,0,0]
  v_pk_fma_f32 v[72:73], v[72:73], v[56:57], v[72:73] neg_lo:[1,0,0] neg_hi:[1,0,0]
  v_pk_fma_f32 v[74:75], v[74:75], v[58:59], v[74:75] neg_lo:[1,0,0] neg_hi:[1,0,0]
  v_pk_fma_f32 v[76:77], v[76:77], v[60:61], v[76:77] neg_lo:[1,0,0] neg_hi:[1,0,0]
  v_pk_fma_f32 v[78:79], v[78:79], v[62:63], v[78:79] neg_lo:[1,0,0] neg_hi:[1,0,0]
  v_cvt_pk_bf16_f32 v64, v64, v65
  v_cvt_pk_bf16_f32 v65, v66, v67
  v_cvt_pk_bf16_f32 v66, v68, v69
  v_cvt_pk_bf16_f32 v67, v70, v71
  v_cvt_pk_bf16_f32 v68, v72, v73
  v_cvt_pk_bf16_f32 v69, v74, v75
  v_cvt_pk_bf16_f32 v70, v76, v77
  v_cvt_pk_bf16_f32 v71, v78, v79
  buffer_store_dwordx4 v[64:67], v16, s[20:23], s73 offen sc1
  buffer_store_dwordx4 v[68:71], v16, s[20:23], s73 offen offset:1024 sc1
  s_waitcnt lgkmcnt(0)
  s_barrier
  s_branch k1_phase2
k1_N:
  s_waitcnt vmcnt(11)
  s_barrier
  ds_read_b128 v[128:131], v8 offset:0
  ds_read_b64_tr_b16 v[96:97], v12 offset:0
  ds_read_b64_tr_b16 v[98:99], v12 offset:512
  ds_read_b64_tr_b16 v[100:101], v13 offset:0
  ds_read_b64_tr_b16 v[102:103], v13 offset:512
  ds_read_b128 v[132:135], v9 offset:0
  ds_read_b64_tr_b16 v[104:105], v12 offset:2048
  ds_read_b64_tr_b16 v[106:107], v12 offset:2560
  ds_read_b64_tr_b16 v[108:109], v13 offset:2048
  ds_read_b64_tr_b16 v[110:111], v13 offset:2560
  s_waitcnt lgkmcnt(5)
  v_mfma_f32_32x32x16_bf16 v[64:79], v[128:131], v[96:99], v[64:79]
  ds_read_b128 v[136:139], v10 offset:0
  ds_read_b64_tr_b16 v[112:113], v12 offset:4096
  ds_read_b64_tr_b16 v[114:115], v12 offset:4608
  v_mfma_f32_32x32x16_bf16 v[80:95], v[128:131], v[100:103], v[80:95]
  ds_read_b64_tr_b16 v[116:117], v13 offset:4096
  ds_read_b64_tr_b16 v[118:119], v13 offset:4608
  s_waitcnt lgkmcnt(5)
  v_mfma_f32_32x32x16_bf16 v[64:79], v[132:135], v[104:107], v[64:79]
  ds_read_b128 v[140:143], v11 offset:0
  ds_read_b64_tr_b16 v[120:121], v12 offset:6144
  ds_read_b64_tr_b16 v[122:123], v12 offset:6656
  v_mfma_f32_32x32x16_bf16 v[80:95], v[132:135], v[108:111], v[80:95]
  ds_read_b64_tr_b16 v[124:125], v13 offset:6144
  ds_read_b64_tr_b16 v[126:127], v13 offset:6656
  s_waitcnt lgkmcnt(5)
  s_waitcnt vmcnt(4)
  s_barrier
  s_lshl_b32 s73, s56, 11
  s_add_u32 s73, s73, 71936
  v_add_u32 v24, s73, v14
  v_add_u32 v25, s73, v15
  ds_read_b64_tr_b16 v[60:61], v24 offset:0
  ds_read_b64_tr_b16 v[62:63], v24 offset:512
  ds_read_b64_tr_b16 v[28:29], v25 offset:0
  ds_read_b64_tr_b16 v[30:31], v25 offset:512
  v_mfma_f32_32x32x16_bf16 v[64:79], v[136:139], v[112:115], v[64:79]
  s_add_u32 m0, s64, 49152
  ds_read_b128 v[144:147], v8 offset:16384
  ds_read_b64_tr_b16 v[96:97], v12 offset:16384
  ds_read_b64_tr_b16 v[98:99], v12 offset:16896
  v_mfma_f32_32x32x16_bf16 v[80:95], v[136:139], v[116:119], v[80:95]
  ds_read_b64_tr_b16 v[100:101], v13 offset:16384
  ds_read_b64_tr_b16 v[102:103], v13 offset:16896
  buffer_load_dwordx4 v2, s[8:11], s63 offen lds
  v_lshlrev_b32 v36, 16, v32
  v_and_b32 v37, 0xffff0000, v32
  v_lshlrev_b32 v38, 16, v33
  v_and_b32 v39, 0xffff0000, v33
  v_lshlrev_b32 v40, 16, v34
  v_and_b32 v41, 0xffff0000, v34
  v_lshlrev_b32 v42, 16, v35
  v_and_b32 v43, 0xffff0000, v35
  v_add_f32 v44, v36, v37
  v_mul_f32 v45, v36, v36
  v_fma_f32 v45, v37, v37, v45
  v_add_f32 v44, v44, v38
  v_fma_f32 v45, v38, v38, v45
  v_add_f32 v44, v44, v39
  v_fma_f32 v45, v39, v39, v45
  s_waitcnt lgkmcnt(9)
  v_mfma_f32_32x32x16_bf16 v[64:79], v[140:143], v[120:123], v[64:79]
  ds_read_b128 v[148:151], v9 offset:16384
  ds_read_b64_tr_b16 v[104:105], v12 offset:18432
  ds_read_b64_tr_b16 v[106:107], v12 offset:18944
  v_mfma_f32_32x32x16_bf16 v[80:95], v[140:143], v[124:127], v[80:95]
  ds_read_b64_tr_b16 v[108:109], v13 offset:18432
  ds_read_b64_tr_b16 v[110:111], v13 offset:18944
  buffer_load_dwordx4 v3, s[8:11], s63 offen offset:1024 lds
  s_add_u32 s63, s63, 128
  v_add_f32 v44, v44, v40
  v_fma_f32 v45, v40, v40, v45
  v_add_f32 v44, v44, v41
  v_fma_f32 v45, v41, v41, v45
  v_add_f32 v44, v44, v42
  v_fma_f32 v45, v42, v42, v45
  v_add_f32 v44, v44, v43
  v_fma_f32 v45, v43, v43, v45
  s_nop 1
  v_add_f32_dpp v44, v44, v44 row_ror:8 row_mask:0xf bank_mask:0xf
  v_add_f32_dpp v45, v45, v45 row_ror:8 row_mask:0xf bank_mask:0xf
  s_nop 1
  v_add_f32_dpp v44, v44, v44 row_ror:4 row_mask:0xf bank_mask:0xf
  v_add_f32_dpp v45, v45, v45 row_ror:4 row_mask:0xf bank_mask:0xf
  s_nop 1
  v_mov_b32 v23, 0
  buffer_load_dword v23, v23, s[4:7], 0 offen sc1
  s_waitcnt lgkmcnt(5)
  v_mfma_f32_16x16x32_bf16 v[48:51], v[60:63], v[56:59], 0
  v_mfma_f32_16x16x32_bf16 v[52:55], v[28:31], v[56:59], 0
  v_mfma_f32_32x32x16_bf16 v[64:79], v[144:147], v[96:99], v[64:79]
  s_add_u32 m0, s66, 114688
  ds_read_b128 v[152:155], v10 offset:16384
  ds_read_b64_tr_b16 v[112:113], v12 offset:20480
  ds_read_b64_tr_b16 v[114:115], v12 offset:20992
  v_mfma_f32_32x32x16_bf16 v[80:95], v[144:147], v[100:103], v[80:95]
  ds_read_b64_tr_b16 v[116:117], v13 offset:20480
  ds_read_b64_tr_b16 v[118:119], v13 offset:20992
  buffer_load_dwordx4 v4, s[12:15], s65 offen lds
  v_add_f32_dpp v44, v44, v44 row_ror:2 row_mask:0xf bank_mask:0xf
  v_add_f32_dpp v45, v45, v45 row_ror:2 row_mask:0xf bank_mask:0xf
  s_nop 1
  v_add_f32_dpp v44, v44, v44 row_ror:1 row_mask:0xf bank_mask:0xf
  v_add_f32_dpp v45, v45, v45 row_ror:1 row_mask:0xf bank_mask:0xf
  v_mov_b32 v36, v44
  v_mov_b32 v37, v45
  s_nop 1
  v_permlane16_swap_b32 v44, v36
  v_permlane16_swap_b32 v45, v37
  s_nop 1
  v_add_f32 v44, v44, v36
  v_add_f32 v45, v45, v37
  v_mov_b32 v36, v44
  v_mov_b32 v37, v45
  v_and_b32 v27, 15, v0
  v_lshrrev_b32 v26, 4, v0
  v_lshlrev_b32 v26, 7, v26
  v_lshl_add_u32 v26, v27, 9, v26
  s_lshl_b32 s73, s56, 2
  s_add_u32 s73, s73, 135168
  v_add_u32 v26, s73, v26
  v_cmp_gt_u32 vcc, 2, v27
  s_and_saveexec_b64 s[74:75], vcc
  ds_write_b32 v26, v48 offset:0
  ds_write_b32 v26, v49 offset:32
  ds_write_b32 v26, v50 offset:64
  ds_write_b32 v26, v51 offset:96
  ds_write_b32 v26, v52 offset:1024
  ds_write_b32 v26, v53 offset:1056
  ds_write_b32 v26, v54 offset:1088
  ds_write_b32 v26, v55 offset:1120
  s_mov_b64 exec, s[74:75]
  buffer_load_ushort v21, v21, s[24:27], s32 offen
  s_waitcnt lgkmcnt(13)
  v_mfma_f32_32x32x16_bf16 v[64:79], v[148:151], v[104:107], v[64:79]
  ds_read_b128 v[156:159], v11 offset:16384
  ds_read_b64_tr_b16 v[120:121], v12 offset:22528
  ds_read_b64_tr_b16 v[122:123], v12 offset:23040
  v_mfma_f32_32x32x16_bf16 v[80:95], v[148:151], v[108:111], v[80:95]
  ds_read_b64_tr_b16 v[124:125], v13 offset:22528
  ds_read_b64_tr_b16 v[126:127], v13 offset:23040
  buffer_load_dwordx4 v5, s[12:15], s65 offen offset:1024 lds
  s_add_u32 s65, s65, s67
  s_nop 1
  v_permlane32_swap_b32 v44, v36
  v_permlane32_swap_b32 v45, v37
  s_nop 1
  v_add_f32 v44, v44, v36
  v_add_f32 v45, v45, v37
  v_mul_f32 v44, 0x3b000000, v44
  v_mul_f32 v45, 0x3b000000, v45
  v_fma_f32 v45, -v44, v44, v45
  v_max_f32 v45, 0, v45
  v_add_f32 v45, 0x3727c5ac, v45
  v_rsq_f32 v32, v45
  v_sub_f32 v33, 0, v44
  v_mul_f32 v34, v33, v32
  v_mov_b32 v35, 0
  s_lshl_b32 s73, s2, 3
  s_add_u32 s73, s73, s56
  s_lshl_b32 s73, s73, 4
  s_add_u32 s73, s73, 21004288
  v_mov_b32 v24, 0
  s_mov_b64 exec, 1
  buffer_store_dwordx4 v[32:35], v24, s[20:23], s73 offen sc1
  s_mov_b64 exec, -1
  s_waitcnt lgkmcnt(13)
  s_waitcnt lgkmcnt(5)
  s_waitcnt vmcnt(7)
  s_barrier
  v_lshlrev_b32 v24, 5, v0
  v_add_u32 v24, 135168, v24
  ds_read_b128 v[48:51], v24
  ds_read_b128 v[52:55], v24 offset:16
  v_mfma_f32_32x32x16_bf16 v[64:79], v[152:155], v[112:115], v[64:79]
  s_add_u32 m0, s64, 0
  ds_read_b128 v[160:163], v8 offset:32768
  ds_read_b64_tr_b16 v[96:97], v12 offset:32768
  ds_read_b64_tr_b16 v[98:99], v12 offset:33280
  v_mfma_f32_32x32x16_bf16 v[80:95], v[152:155], v[116:119], v[80:95]
  ds_read_b64_tr_b16 v[100:101], v13 offset:32768
  ds_read_b64_tr_b16 v[102:103], v13 offset:33280
  buffer_load_dwordx4 v2, s[8:11], s63 offen lds
  s_waitcnt lgkmcnt(7)
  v_mfma_f32_32x32x16_bf16 v[64:79], v[156:159], v[120:123], v[64:79]
  ds_read_b128 v[164:167], v9 offset:32768
  ds_read_b64_tr_b16 v[104:105], v12 offset:34816
  ds_read_b64_tr_b16 v[106:107], v12 offset:35328
  v_mfma_f32_32x32x16_bf16 v[80:95], v[156:159], v[124:127], v[80:95]
  ds_read_b64_tr_b16 v[108:109], v13 offset:34816
  ds_read_b64_tr_b16 v[110:111], v13 offset:35328
  buffer_load_dwordx4 v3, s[8:11], s63 offen offset:1024 lds
  s_add_u32 s63, s63, 128
  s_waitcnt lgkmcnt(10)
  v_add_f32 v48, v48, v52
  v_add_f32 v49, v49, v53
  v_add_f32 v50, v50, v54
  v_add_f32 v51, v51, v55
  s_lshl_b32 s73, s2, 8
  s_add_u32 s73, s73, 21069824
  s_cmp_lt_u32 s2, 208
  s_cselect_b32 s73, s73, 0x20000000
  v_add_f32 v48, v48, v49
  v_add_f32 v50, v50, v51
  s_cmp_eq_u32 s56, 0
  s_cselect_b32 s73, s73, 0x20000000
  v_lshlrev_b32 v24, 2, v0
  v_add_f32 v48, v48, v50
  buffer_store_dword v48, v24, s[20:23], s73 offen sc1
  s_waitcnt lgkmcnt(5)
  v_mfma_f32_32x32x16_bf16 v[64:79], v[160:163], v[96:99], v[64:79]
  s_add_u32 m0, s66, 65536
  ds_read_b128 v[168:171], v10 offset:32768
  ds_read_b64_tr_b16 v[112:113], v12 offset:36864
  ds_read_b64_tr_b16 v[114:115], v12 offset:37376
  v_mfma_f32_32x32x16_bf16 v[80:95], v[160:163], v[100:103], v[80:95]
  ds_read_b64_tr_b16 v[116:117], v13 offset:36864
  ds_read_b64_tr_b16 v[118:119], v13 offset:37376
  buffer_load_dwordx4 v4, s[12:15], s65 offen lds
  s_waitcnt lgkmcnt(5)
  v_mfma_f32_32x32x16_bf16 v[64:79], v[164:167], v[104:107], v[64:79]
  ds_read_b128 v[172:175], v11 offset:32768
  ds_read_b64_tr_b16 v[120:121], v12 offset:38912
  ds_read_b64_tr_b16 v[122:123], v12 offset:39424
  v_mfma_f32_32x32x16_bf16 v[80:95], v[164:167], v[108:111], v[80:95]
  ds_read_b64_tr_b16 v[124:125], v13 offset:38912
  ds_read_b64_tr_b16 v[126:127], v13 offset:39424
  buffer_load_dwordx4 v5, s[12:15], s65 offen offset:1024 lds
  s_add_u32 s65, s65, s67
  s_waitcnt lgkmcnt(5)
  s_waitcnt vmcnt(6)
  s_barrier
  v_mfma_f32_32x32x16_bf16 v[64:79], v[168:171], v[112:115], v[64:79]
  s_add_u32 m0, s64, 16384
  ds_read_b128 v[176:179], v8 offset:49152
  ds_read_b64_tr_b16 v[96:97], v12 offset:49152
  ds_read_b64_tr_b16 v[98:99], v12 offset:49664
  v_mfma_f32_32x32x16_bf16 v[80:95], v[168:171], v[116:119], v[80:95]
  ds_read_b64_tr_b16 v[100:101], v13 offset:49152
  ds_read_b64_tr_b16 v[102:103], v13 offset:49664
  buffer_load_dwordx4 v2, s[8:11], s63 offen lds
  s_waitcnt lgkmcnt(5)
  v_mfma_f32_32x32x16_bf16 v[64:79], v[172:175], v[120:123], v[64:79]
  ds_read_b128 v[180:183], v9 offset:49152
  ds_read_b64_tr_b16 v[104:105], v12 offset:51200
  ds_read_b64_tr_b16 v[106:107], v12 offset:51712
  v_mfma_f32_32x32x16_bf16 v[80:95], v[172:175], v[124:127], v[80:95]
  ds_read_b64_tr_b16 v[108:109], v13 offset:51200
  ds_read_b64_tr_b16 v[110:111], v13 offset:51712
  buffer_load_dwordx4 v3, s[8:11], s63 offen offset:1024 lds
  s_add_u32 s63, s63, 128
  s_waitcnt lgkmcnt(5)
  v_mfma_f32_32x32x16_bf16 v[64:79], v[176:179], v[96:99], v[64:79]
  s_add_u32 m0, s66, 81920
  ds_read_b128 v[184:187], v10 offset:49152
  ds_read_b64_tr_b16 v[112:113], v12 offset:53248
  ds_read_b64_tr_b16 v[114:115], v12 offset:53760
  v_mfma_f32_32x32x16_bf16 v[80:95], v[176:179], v[100:103], v[80:95]
  ds_read_b64_tr_b16 v[116:117], v13 offset:53248
  ds_read_b64_tr_b16 v[118:119], v13 offset:53760
  buffer_load_dwordx4 v4, s[12:15], s65 offen lds
  s_waitcnt lgkmcnt(5)
  v_mfma_f32_32x32x16_bf16 v[64:79], v[180:183], v[104:107], v[64:79]
  ds_read_b128 v[188:191], v11 offset:49152
  ds_read_b64_tr_b16 v[120:121], v12 offset:55296
  ds_read_b64_tr_b16 v[122:123], v12 offset:55808
  v_mfma_f32_32x32x16_bf16 v[80:95], v[180:183], v[108:111], v[80:95]
  ds_read_b64_tr_b16 v[124:125], v13 offset:55296
  ds_read_b64_tr_b16 v[126:127], v13 offset:55808
  buffer_load_dwordx4 v5, s[12:15], s65 offen offset:1024 lds
  s_add_u32 s65, s65, s67
  s_waitcnt lgkmcnt(5)
  s_waitcnt vmcnt(4)
  s_barrier
  v_readfirstlane_b32 s90, v23
  s_mov_b32 s77, 0
k1_nqN0:
  s_cmp_lg_u32 s90, 0
  s_cbranch_scc1 k1_nokN0
  v_mov_b32 v23, 0
  buffer_load_dword v23, v23, s[4:7], 0 offen sc1
  s_waitcnt vmcnt(0)
  v_readfirstlane_b32 s90, v23
  s_add_u32 s77, s77, 1
  s_cmp_lt_u32 s77, 200000
  s_cbranch_scc1 k1_nqN0
k1_nokN0:
  s_cmp_eq_u32 s56, 0
  s_cbranch_scc0 k1_pfN0
  s_lshl_b32 s73, s2, 2
  s_add_u32 s73, s73, 20987904
  v_mov_b32 v24, s90
  v_mov_b32 v25, 0
  s_mov_b64 exec, 1
  buffer_store_dword v24, v25, s[20:23], s73 offen sc1
  s_mov_b64 exec, -1
k1_pfN0:
  v_mfma_f32_32x32x16_bf16 v[64:79], v[184:187], v[112:115], v[64:79]
  s_add_u32 m0, s64, 32768
  ds_read_b128 v[192:195], v8 offset:0
  ds_read_b64_tr_b16 v[96:97], v12 offset:0
  ds_read_b64_tr_b16 v[98:99], v12 offset:512
  v_mfma_f32_32x32x16_bf16 v[80:95], v[184:187], v[116:119], v[80:95]
  ds_read_b64_tr_b16 v[100:101], v13 offset:0
  ds_read_b64_tr_b16 v[102:103], v13 offset:512
  buffer_load_dwordx4 v2, s[8:11], s63 offen lds
  v_lshlrev_b32 v21, 16, v21
  v_and_b32 v24, 31, v0
  s_lshl_b32 s73, s56, 7
  s_add_u32 s73, s73, 134144
  v_lshl_add_u32 v24, v24, 2, s73
  ds_write_b32 v24, v21
  s_waitcnt lgkmcnt(6)
  v_mfma_f32_32x32x16_bf16 v[64:79], v[188:191], v[120:123], v[64:79]
  ds_read_b128 v[196:199], v9 offset:0
  ds_read_b64_tr_b16 v[104:105], v12 offset:2048
  ds_read_b64_tr_b16 v[106:107], v12 offset:2560
  v_mfma_f32_32x32x16_bf16 v[80:95], v[188:191], v[124:127], v[80:95]
  ds_read_b64_tr_b16 v[108:109], v13 offset:2048
  ds_read_b64_tr_b16 v[110:111], v13 offset:2560
  buffer_load_dwordx4 v3, s[8:11], s63 offen offset:1024 lds
  s_add_u32 s63, s63, 128
  s_waitcnt lgkmcnt(6)
  v_mfma_f32_32x32x16_bf16 v[64:79], v[192:195], v[96:99], v[64:79]
  s_add_u32 m0, s66, 98304
  ds_read_b128 v[200:203], v10 offset:0
  ds_read_b64_tr_b16 v[112:113], v12 offset:4096
  ds_read_b64_tr_b16 v[114:115], v12 offset:4608
  v_mfma_f32_32x32x16_bf16 v[80:95], v[192:195], v[100:103], v[80:95]
  ds_read_b64_tr_b16 v[116:117], v13 offset:4096
  ds_read_b64_tr_b16 v[118:119], v13 offset:4608
  buffer_load_dwordx4 v4, s[12:15], s65 offen lds
  s_waitcnt lgkmcnt(5)
  v_mfma_f32_32x32x16_bf16 v[64:79], v[196:199], v[104:107], v[64:79]
  ds_read_b128 v[204:207], v11 offset:0
  ds_read_b64_tr_b16 v[120:121], v12 offset:6144
  ds_read_b64_tr_b16 v[122:123], v12 offset:6656
  v_mfma_f32_32x32x16_bf16 v[80:95], v[196:199], v[108:111], v[80:95]
  ds_read_b64_tr_b16 v[124:125], v13 offset:6144
  ds_read_b64_tr_b16 v[126:127], v13 offset:6656
  buffer_load_dwordx4 v5, s[12:15], s65 offen offset:1024 lds
  s_add_u32 s65, s65, s67
  s_waitcnt lgkmcnt(5)
  s_waitcnt vmcnt(4)
  s_barrier
  v_mfma_f32_32x32x16_bf16 v[64:79], v[200:203], v[112:115], v[64:79]
  s_add_u32 m0, s64, 49152
  ds_read_b128 v[208:211], v8 offset:16384
  ds_read_b64_tr_b16 v[96:97], v12 offset:16384
  ds_read_b64_tr_b16 v[98:99], v12 offset:16896
  v_mfma_f32_32x32x16_bf16 v[80:95], v[200:203], v[116:119], v[80:95]
  ds_read_b64_tr_b16 v[100:101], v13 offset:16384
  ds_read_b64_tr_b16 v[102:103], v13 offset:16896
  buffer_load_dwordx4 v2, s[8:11], s63 offen lds
  s_waitcnt lgkmcnt(5)
  v_mfma_f32_32x32x16_bf16 v[64:79], v[204:207], v[120:123], v[64:79]
  ds_read_b128 v[212:215], v9 offset:16384
  ds_read_b64_tr_b16 v[104:105], v12 offset:18432
  ds_read_b64_tr_b16 v[106:107], v12 offset:18944
  v_mfma_f32_32x32x16_bf16 v[80:95], v[204:207], v[124:127], v[80:95]
  ds_read_b64_tr_b16 v[108:109], v13 offset:18432
  ds_read_b64_tr_b16 v[110:111], v13 offset:18944
  buffer_load_dwordx4 v3, s[8:11], s63 offen offset:1024 lds
  s_add_u32 s63, s63, 128
  s_waitcnt lgkmcnt(5)
  v_mfma_f32_32x32x16_bf16 v[64:79], v[208:211], v[96:99], v[64:79]
  s_add_u32 m0, s66, 114688
  ds_read_b128 v[216:219], v10 offset:16384
  ds_read_b64_tr_b16 v[112:113], v12 offset:20480
  ds_read_b64_tr_b16 v[114:115], v12 offset:20992
  v_mfma_f32_32x32x16_bf16 v[80:95], v[208:211], v[100:103], v[80:95]
  ds_read_b64_tr_b16 v[116:117], v13 offset:20480
  ds_read_b64_tr_b16 v[118:119], v13 offset:20992
  buffer_load_dwordx4 v4, s[12:15], s65 offen lds
  s_waitcnt lgkmcnt(5)
  v_mfma_f32_32x32x16_bf16 v[64:79], v[212:215], v[104:107], v[64:79]
  ds_read_b128 v[220:223], v11 offset:16384
  ds_read_b64_tr_b16 v[120:121], v12 offset:22528
  ds_read_b64_tr_b16 v[122:123], v12 offset:23040
  v_mfma_f32_32x32x16_bf16 v[80:95], v[212:215], v[108:111], v[80:95]
  ds_read_b64_tr_b16 v[124:125], v13 offset:22528
  ds_read_b64_tr_b16 v[126:127], v13 offset:23040
  buffer_load_dwordx4 v5, s[12:15], s65 offen offset:1024 lds
  s_add_u32 s65, s65, s67
  buffer_load_dword v31, v46, s[20:23], 0 offen sc1
  s_waitcnt lgkmcnt(5)
  s_waitcnt vmcnt(5)
  s_barrier
  v_mfma_f32_32x32x16_bf16 v[64:79], v[216:219], v[112:115], v[64:79]
  s_add_u32 m0, s69, 65536
  ds_read_b128 v[224:227], v8 offset:32768
  ds_read_b64_tr_b16 v[96:97], v12 offset:32768
  ds_read_b64_tr_b16 v[98:99], v12 offset:33280
  v_mfma_f32_32x32x16_bf16 v[80:95], v[216:219], v[116:119], v[80:95]
  ds_read_b64_tr_b16 v[100:101], v13 offset:32768
  ds_read_b64_tr_b16 v[102:103], v13 offset:33280
  buffer_load_dwordx4 v6, s[16:19], s68 offen lds
  s_waitcnt lgkmcnt(5)
  v_mfma_f32_32x32x16_bf16 v[64:79], v[220:223], v[120:123], v[64:79]
  ds_read_b128 v[228:231], v9 offset:32768
  ds_read_b64_tr_b16 v[104:105], v12 offset:34816
  ds_read_b64_tr_b16 v[106:107], v12 offset:35328
  v_mfma_f32_32x32x16_bf16 v[80:95], v[220:223], v[124:127], v[80:95]
  ds_read_b64_tr_b16 v[108:109], v13 offset:34816
  ds_read_b64_tr_b16 v[110:111], v13 offset:35328
  buffer_load_dwordx4 v7, s[16:19], s68 offen offset:1024 lds
  s_add_u32 s68, s68, 458752
  s_waitcnt lgkmcnt(5)
  v_mfma_f32_32x32x16_bf16 v[64:79], v[224:227], v[96:99], v[64:79]
  s_add_u32 m0, s69, 0
  ds_read_b128 v[232:235], v10 offset:32768
  ds_read_b64_tr_b16 v[112:113], v12 offset:36864
  ds_read_b64_tr_b16 v[114:115], v12 offset:37376
  v_mfma_f32_32x32x16_bf16 v[80:95], v[224:227], v[100:103], v[80:95]
  ds_read_b64_tr_b16 v[116:117], v13 offset:36864
  ds_read_b64_tr_b16 v[118:119], v13 offset:37376
  buffer_load_dwordx4 v6, s[16:19], s70 offen lds
  s_waitcnt lgkmcnt(5)
  v_mfma_f32_32x32x16_bf16 v[64:79], v[228:231], v[104:107], v[64:79]
  ds_read_b128 v[236:239], v11 offset:32768
  ds_read_b64_tr_b16 v[120:121], v12 offset:38912
  ds_read_b64_tr_b16 v[122:123], v12 offset:39424
  v_mfma_f32_32x32x16_bf16 v[80:95], v[228:231], v[108:111], v[80:95]
  ds_read_b64_tr_b16 v[124:125], v13 offset:38912
  ds_read_b64_tr_b16 v[126:127], v13 offset:39424
  buffer_load_dwordx4 v7, s[16:19], s70 offen offset:1024 lds
  s_add_u32 s70, s70, 458752
  s_waitcnt lgkmcnt(5)
  s_waitcnt vmcnt(5)
  s_barrier
  s_waitcnt vmcnt(4)
  s_mov_b32 s77, 0
k1_cpN0:
  v_cmp_eq_u32 vcc, s90, v31
  s_add_u32 s77, s77, 1
  s_cmp_eq_u64 vcc, exec
  s_cbranch_scc1 k1_cfN0
  s_cmp_gt_u32 s77, 200000
  s_cbranch_scc1 k1_cfN0
  buffer_load_dword v31, v46, s[20:23], 0 offen sc1
  s_waitcnt vmcnt(0)
  s_branch k1_cpN0
k1_cfN0:
  buffer_load_dwordx4 v[32:35], v16, s[20:23], s92 offen sc1
  buffer_load_dword v36, v47, s[20:23], s93 offen offset:0 sc1
  buffer_load_dword v37, v47, s[20:23], s93 offen offset:256 sc1
  buffer_load_dword v38, v47, s[20:23], s93 offen offset:512 sc1
  buffer_load_dword v39, v47, s[20:23], s93 offen offset:768 sc1
  v_mfma_f32_32x32x16_bf16 v[64:79], v[232:235], v[112:115], v[64:79]
  s_add_u32 m0, s69, 81920
  ds_read_b128 v[240:243], v8 offset:49152
  ds_read_b64_tr_b16 v[96:97], v12 offset:49152
  ds_read_b64_tr_b16 v[98:99], v12 offset:49664
  v_mfma_f32_32x32x16_bf16 v[80:95], v[232:235], v[116:119], v[80:95]
  ds_read_b64_tr_b16 v[100:101], v13 offset:49152
  ds_read_b64_tr_b16 v[102:103], v13 offset:49664
  buffer_load_dwordx4 v6, s[16:19], s68 offen lds
  s_waitcnt lgkmcnt(5)
  v_mfma_f32_32x32x16_bf16 v[64:79], v[236:239], v[120:123], v[64:79]
  ds_read_b128 v[244:247], v9 offset:49152
  ds_read_b64_tr_b16 v[104:105], v12 offset:51200
  ds_read_b64_tr_b16 v[106:107], v12 offset:51712
  v_mfma_f32_32x32x16_bf16 v[80:95], v[236:239], v[124:127], v[80:95]
  ds_read_b64_tr_b16 v[108:109], v13 offset:51200
  ds_read_b64_tr_b16 v[110:111], v13 offset:51712
  buffer_load_dwordx4 v7, s[16:19], s68 offen offset:1024 lds
  s_add_u32 s68, s68, 458752
  s_waitcnt lgkmcnt(5)
  v_mfma_f32_32x32x16_bf16 v[64:79], v[240:243], v[96:99], v[64:79]
  s_add_u32 m0, s69, 16384
  ds_read_b128 v[248:251], v10 offset:49152
  ds_read_b64_tr_b16 v[112:113], v12 offset:53248
  ds_read_b64_tr_b16 v[114:115], v12 offset:53760
  v_mfma_f32_32x32x16_bf16 v[80:95], v[240:243], v[100:103], v[80:95]
  ds_read_b64_tr_b16 v[116:117], v13 offset:53248
  ds_read_b64_tr_b16 v[118:119], v13 offset:53760
  buffer_load_dwordx4 v6, s[16:19], s70 offen lds
  s_waitcnt lgkmcnt(5)
  v_mfma_f32_32x32x16_bf16 v[64:79], v[244:247], v[104:107], v[64:79]
  ds_read_b128 v[252:255], v11 offset:49152
  ds_read_b64_tr_b16 v[120:121], v12 offset:55296
  ds_read_b64_tr_b16 v[122:123], v12 offset:55808
  v_mfma_f32_32x32x16_bf16 v[80:95], v[244:247], v[108:111], v[80:95]
  ds_read_b64_tr_b16 v[124:125], v13 offset:55296
  ds_read_b64_tr_b16 v[126:127], v13 offset:55808
  buffer_load_dwordx4 v7, s[16:19], s70 offen offset:1024 lds
  s_add_u32 s70, s70, 458752
  s_waitcnt lgkmcnt(5)
  s_barrier
  v_mfma_f32_32x32x16_bf16 v[64:79], v[248:251], v[112:115], v[64:79]
  s_add_u32 m0, s69, 98304
  v_mfma_f32_32x32x16_bf16 v[80:95], v[248:251], v[116:119], v[80:95]
  s_nop 0
  buffer_load_dwordx4 v6, s[16:19], s68 offen lds
  s_waitcnt lgkmcnt(0)
  v_mfma_f32_32x32x16_bf16 v[64:79], v[252:255], v[120:123], v[64:79]
  v_mfma_f32_32x32x16_bf16 v[80:95], v[252:255], v[124:127], v[80:95]
  buffer_load_dwordx4 v7, s[16:19], s68 offen offset:1024 lds
  s_add_u32 s68, s68, 458752
  s_add_u32 m0, s69, 32768
  s_nop 0
  buffer_load_dwordx4 v6, s[16:19], s70 offen lds
  buffer_load_dwordx4 v7, s[16:19], s70 offen offset:1024 lds
  s_add_u32 s70, s70, 458752
  s_waitcnt vmcnt(8)
  v_add_f32 v36, v36, v37
  v_add_f32 v38, v38, v39
  s_and_b32 s73, s56, 1
  s_lshl_b32 s73, s73, 8
  s_add_u32 s73, s73, 131072
  v_lshl_add_u32 v24, v0, 2, s73
  v_add_f32 v36, v36, v38
  ds_write_b32 v24, v32
  ds_write_b32 v24, v33 offset:512
  ds_write_b32 v24, v34 offset:1024
  s_lshl_b32 s73, s57, 8
  s_add_u32 s73, s73, 133120
  v_lshl_add_u32 v24, v0, 2, s73
  ds_write_b32 v24, v36
  v_and_b32 v24, 31, v0
  s_lshl_b32 s72, s57, 7
  s_add_u32 s72, s72, 131072
  v_lshl_add_u32 v23, v24, 2, s72
  s_waitcnt lgkmcnt(0)
  s_barrier
  s_add_u32 m0, s69, 114688
  s_nop 0
  buffer_load_dwordx4 v6, s[16:19], s68 offen lds
  buffer_load_dwordx4 v7, s[16:19], s68 offen offset:1024 lds
  s_add_u32 s68, s68, 458752
  s_add_u32 m0, s69, 49152
  s_nop 0
  buffer_load_dwordx4 v6, s[16:19], s70 offen lds
  buffer_load_dwordx4 v7, s[16:19], s70 offen offset:1024 lds
  s_add_u32 s70, s70, 458752
  ds_read_b32 v19, v23
  ds_read_b32 v18, v23 offset:512
  v_and_b32 v24, 31, v0
  v_lshrrev_b32 v26, 5, v0
  s_lshl_b32 s72, s57, 7
  s_add_u32 s72, s72, 131072
  v_lshl_add_u32 v26, v26, 4, s72
  v_lshlrev_b32 v27, 2, v24
  v_add_u32 v27, 133120, v27
  ds_read_b32 v30, v27
  ds_read_b32 v31, v27 offset:128
  ds_read_b128 v[32:35], v26 offset:0
  ds_read_b128 v[36:39], v26 offset:32
  ds_read_b128 v[40:43], v26 offset:64
  ds_read_b128 v[44:47], v26 offset:96
  ds_read_b128 v[48:51], v26 offset:1024
  ds_read_b128 v[52:55], v26 offset:1056
  ds_read_b128 v[56:59], v26 offset:1088
  ds_read_b128 v[60:63], v26 offset:1120
  v_lshrrev_b32 v25, 4, v24
  v_lshlrev_b32 v23, 16, v25
  v_and_b32 v25, 15, v24
  v_lshl_add_u32 v23, v25, 4, v23
  v_lshrrev_b32 v25, 5, v0
  v_lshl_add_u32 v23, v25, 8, v23
  s_waitcnt lgkmcnt(0)
  s_lshl_b32 s73, s60, 2
  s_add_u32 s73, s73, 0
  s_lshl_b32 s73, s73, 16
  s_lshl_b32 s74, s62, 10
  s_add_u32 s73, s73, s74
  s_add_u32 s73, s73, 4194304
  v_pk_mul_f32 v[64:65], v[64:65], v[32:33]
  v_pk_mul_f32 v[66:67], v[66:67], v[34:35]
  v_pk_mul_f32 v[68:69], v[68:69], v[36:37]
  v_pk_mul_f32 v[70:71], v[70:71], v[38:39]
  v_pk_mul_f32 v[72:73], v[72:73], v[40:41]
  v_pk_mul_f32 v[74:75], v[74:75], v[42:43]
  v_pk_mul_f32 v[76:77], v[76:77], v[44:45]
  v_pk_mul_f32 v[78:79], v[78:79], v[46:47]
  v_pk_fma_f32 v[64:65], v[48:49], v[30:31], v[64:65] op_sel_hi:[1,0,1]
  v_pk_fma_f32 v[66:67], v[50:51], v[30:31], v[66:67] op_sel_hi:[1,0,1]
  v_pk_fma_f32 v[68:69], v[52:53], v[30:31], v[68:69] op_sel_hi:[1,0,1]
  v_pk_fma_f32 v[70:71], v[54:55], v[30:31], v[70:71] op_sel_hi:[1,0,1]
  v_pk_fma_f32 v[72:73], v[56:57], v[30:31], v[72:73] op_sel_hi:[1,0,1]
  v_pk_fma_f32 v[74:75], v[58:59], v[30:31], v[74:75] op_sel_hi:[1,0,1]
  v_pk_fma_f32 v[76:77], v[60:61], v[30:31], v[76:77] op_sel_hi:[1,0,1]
  v_pk_fma_f32 v[78:79], v[62:63], v[30:31], v[78:79] op_sel_hi:[1,0,1]
  v_max3_f32 v22, |v64|, |v65|, v22
  v_max3_f32 v22, |v66|, |v67|, v22
  v_max3_f32 v22, |v68|, |v69|, v22
  v_max3_f32 v22, |v70|, |v71|, v22
  v_max3_f32 v22, |v72|, |v73|, v22
  v_max3_f32 v22, |v74|, |v75|, v22
  v_max3_f32 v22, |v76|, |v77|, v22
  v_max3_f32 v22, |v78|, |v79|, v22
  v_cvt_pk_bf16_f32 v64, v64, v65
  v_cvt_pk_bf16_f32 v65, v66, v67
  v_cvt_pk_bf16_f32 v66, v68, v69
  v_cvt_pk_bf16_f32 v67, v70, v71
  v_cvt_pk_bf16_f32 v68, v72, v73
  v_cvt_pk_bf16_f32 v69, v74, v75
  v_cvt_pk_bf16_f32 v70, v76, v77
  v_cvt_pk_bf16_f32 v71, v78, v79
  buffer_store_dwordx4 v[64:67], v23, s[20:23], s73 offen sc1
  buffer_store_dwordx4 v[68:71], v23, s[20:23], s73 offen offset:512 sc1
  s_lshl_b32 s73, s60, 2
  s_add_u32 s73, s73, 2
  s_lshl_b32 s73, s73, 16
  s_lshl_b32 s74, s62, 10
  s_add_u32 s73, s73, s74
  s_add_u32 s73, s73, 4194304
  v_pk_mul_f32 v[80:81], v[80:81], v[32:33]
  v_pk_mul_f32 v[82:83], v[82:83], v[34:35]
  v_pk_mul_f32 v[84:85], v[84:85], v[36:37]
  v_pk_mul_f32 v[86:87], v[86:87], v[38:39]
  v_pk_mul_f32 v[88:89], v[88:89], v[40:41]
  v_pk_mul_f32 v[90:91], v[90:91], v[42:43]
  v_pk_mul_f32 v[92:93], v[92:93], v[44:45]
  v_pk_mul_f32 v[94:95], v[94:95], v[46:47]
  v_pk_fma_f32 v[80:81], v[48:49], v[30:31], v[80:81] op_sel:[0,1,0] op_sel_hi:[1,1,1]
  v_pk_fma_f32 v[82:83], v[50:51], v[30:31], v[82:83] op_sel:[0,1,0] op_sel_hi:[1,1,1]
  v_pk_fma_f32 v[84:85], v[52:53], v[30:31], v[84:85] op_sel:[0,1,0] op_sel_hi:[1,1,1]
  v_pk_fma_f32 v[86:87], v[54:55], v[30:31], v[86:87] op_sel:[0,1,0] op_sel_hi:[1,1,1]
  v_pk_fma_f32 v[88:89], v[56:57], v[30:31], v[88:89] op_sel:[0,1,0] op_sel_hi:[1,1,1]
  v_pk_fma_f32 v[90:91], v[58:59], v[30:31], v[90:91] op_sel:[0,1,0] op_sel_hi:[1,1,1]
  v_pk_fma_f32 v[92:93], v[60:61], v[30:31], v[92:93] op_sel:[0,1,0] op_sel_hi:[1,1,1]
  v_pk_fma_f32 v[94:95], v[62:63], v[30:31], v[94:95] op_sel:[0,1,0] op_sel_hi:[1,1,1]
  v_max3_f32 v22, |v80|, |v81|, v22
  v_max3_f32 v22, |v82|, |v83|, v22
  v_max3_f32 v22, |v84|, |v85|, v22
  v_max3_f32 v22, |v86|, |v87|, v22
  v_max3_f32 v22, |v88|, |v89|, v22
  v_max3_f32 v22, |v90|, |v91|, v22
  v_max3_f32 v22, |v92|, |v93|, v22
  v_max3_f32 v22, |v94|, |v95|, v22
  v_cvt_pk_bf16_f32 v80, v80, v81
  v_cvt_pk_bf16_f32 v81, v82, v83
  v_cvt_pk_bf16_f32 v82, v84, v85
  v_cvt_pk_bf16_f32 v83, v86, v87
  v_cvt_pk_bf16_f32 v84, v88, v89
  v_cvt_pk_bf16_f32 v85, v90, v91
  v_cvt_pk_bf16_f32 v86, v92, v93
  v_cvt_pk_bf16_f32 v87, v94, v95
  buffer_store_dwordx4 v[80:83], v23, s[20:23], s73 offen sc1
  buffer_store_dwordx4 v[84:87], v23, s[20:23], s73 offen offset:512 sc1
  s_nop 1
  v_max_f32_dpp v22, v22, v22 row_ror:8 row_mask:0xf bank_mask:0xf
  s_nop 1
  v_max_f32_dpp v22, v22, v22 row_ror:4 row_mask:0xf bank_mask:0xf
  s_nop 1
  v_max_f32_dpp v22, v22, v22 row_ror:2 row_mask:0xf bank_mask:0xf
  s_nop 1
  v_max_f32_dpp v22, v22, v22 row_ror:1 row_mask:0xf bank_mask:0xf
  v_mov_b32 v24, v22
  s_nop 1
  v_permlane16_swap_b32 v22, v24
  s_nop 1
  v_max_f32 v22, v22, v24
  v_mov_b32 v24, v22
  s_nop 1
  v_permlane32_swap_b32 v22, v24
  s_nop 1
  v_max_f32 v22, v22, v24
  s_lshl_b32 s73, s60, 6
  s_add_u32 s73, s73, s62
  s_lshl_b32 s73, s73, 2
  s_add_u32 s73, s73, 6295552
  v_mov_b32 v24, 0
  buffer_store_dword v22, v24, s[20:23], s73 offen sc1
  s_waitcnt vmcnt(5)
  s_barrier
  s_waitcnt vmcnt(0)
  v_mov_b32 v24, 137216
  v_mov_b32 v25, 1
  s_mov_b64 exec, 1
  ds_add_rtn_u32 v26, v24, v25
  s_mov_b64 exec, -1
  s_lshl_b32 s73, s60, 5
  s_lshl_b32 s74, s61, 4
  s_add_u32 s73, s73, s74
  s_add_u32 s73, s73, s59
  s_lshl_b32 s73, s73, 2
  s_add_u32 s73, s73, 20975616
  s_waitcnt lgkmcnt(0)
  v_readfirstlane_b32 s74, v26
  s_cmp_eq_u32 s74, 3
  s_cbranch_scc0 k1_p1ya
  v_mov_b32 v24, s90
  v_mov_b32 v25, 0
  s_mov_b64 exec, 1
  buffer_store_dword v24, v25, s[20:23], s73 offen sc1
  s_mov_b64 exec, -1
k1_p1ya:
  s_lshl_b32 s72, s57, 8
  s_add_u32 s72, s72, s2
  s_lshr_b32 s73, s72, 3
  s_and_b32 s74, s72, 7
  s_cmp_lt_u32 s73, 112
  s_cselect_b32 s28, s48, s40
  s_cselect_b32 s29, s49, s41
  s_mov_b32 s30, 524288
  s_cselect_b32 s30, 1835008, s30
  s_cselect_b32 s75, 0, 112
  s_and_b32 s29, s29, 0xffff
  s_mov_b32 s31, 0x00020000
  s_sub_u32 s75, s73, s75
  s_lshl_b32 s75, s75, 14
  s_lshl_b32 s76, s74, 7
  s_add_u32 s75, s75, s76
  s_mul_i32 s80, s74, 288
  s_add_u32 s80, s80, s73
  s_lshl_b32 s80, s80, 10
  s_add_u32 s80, s80, 7340032
  s_cmp_lt_u32 s72, 1152
  s_cselect_b32 s80, s80, 0x20000000
  s_cselect_b32 s75, s75, 0x20000000
  v_lshrrev_b32 v24, 3, v0
  v_and_b32 v25, 7, v0
  v_bfe_u32 v26, v0, 4, 1
  v_lshlrev_b32 v26, 2, v26
  v_xor_b32 v25, v25, v26
  v_lshlrev_b32 v25, 4, v25
  v_lshl_add_u32 v24, v24, 10, v25
  v_add_u32 v25, 7168, v24
  s_xor_b32 s76, s64, 0
  s_add_u32 m0, s76, 137472
  s_nop 0
  buffer_load_dwordx4 v24, s[28:31], s75 offen lds
  buffer_load_dwordx4 v25, s[28:31], s75 offen offset:1024 lds
  s_add_u32 s72, s2, 1024
  s_cmp_eq_u32 s57, 0
  s_cselect_b32 s72, s72, 0x7fff
  s_lshr_b32 s73, s72, 3
  s_and_b32 s74, s72, 7
  s_cmp_lt_u32 s73, 112
  s_cselect_b32 s28, s48, s40
  s_cselect_b32 s29, s49, s41
  s_mov_b32 s30, 524288
  s_cselect_b32 s30, 1835008, s30
  s_cselect_b32 s75, 0, 112
  s_and_b32 s29, s29, 0xffff
  s_mov_b32 s31, 0x00020000
  s_sub_u32 s75, s73, s75
  s_lshl_b32 s75, s75, 14
  s_lshl_b32 s76, s74, 7
  s_add_u32 s75, s75, s76
  s_mul_i32 s33, s74, 288
  s_add_u32 s33, s33, s73
  s_lshl_b32 s33, s33, 10
  s_add_u32 s33, s33, 7340032
  s_cmp_lt_u32 s72, 1152
  s_cselect_b32 s33, s33, 0x20000000
  s_cselect_b32 s75, s75, 0x20000000
  v_lshrrev_b32 v24, 3, v0
  v_and_b32 v25, 7, v0
  v_bfe_u32 v26, v0, 4, 1
  v_lshlrev_b32 v26, 2, v26
  v_xor_b32 v25, v25, v26
  v_lshlrev_b32 v25, 4, v25
  v_lshl_add_u32 v24, v24, 10, v25
  v_add_u32 v25, 7168, v24
  s_xor_b32 s76, s64, 8192
  s_add_u32 m0, s76, 137472
  s_nop 0
  buffer_load_dwordx4 v24, s[28:31], s75 offen lds
  buffer_load_dwordx4 v25, s[28:31], s75 offen offset:1024 lds
  s_add_u32 s83, s81, 256
  s_lshr_b32 s83, s83, 1
  ds_read_b64_tr_b16 v[96:97], v14 offset:0
  ds_read_b64_tr_b16 v[98:99], v14 offset:512
  ds_read_b64_tr_b16 v[100:101], v14 offset:2048
  ds_read_b64_tr_b16 v[102:103], v14 offset:2560
  ds_read_b64_tr_b16 v[104:105], v14 offset:4096
  ds_read_b64_tr_b16 v[106:107], v14 offset:4608
  s_waitcnt lgkmcnt(4)
  v_mfma_f32_32x32x16_bf16 v[64:79], v[96:99], v[128:131], 0
  ds_read_b64_tr_b16 v[108:109], v14 offset:6144
  ds_read_b64_tr_b16 v[110:111], v14 offset:6656
  s_waitcnt lgkmcnt(4)
  v_mfma_f32_32x32x16_bf16 v[64:79], v[100:103], v[132:135], v[64:79]
  ds_read_b64_tr_b16 v[96:97], v14 offset:8192
  ds_read_b64_tr_b16 v[98:99], v14 offset:8704
  s_waitcnt lgkmcnt(4)
  v_mfma_f32_32x32x16_bf16 v[64:79], v[104:107], v[136:139], v[64:79]
  ds_read_b64_tr_b16 v[100:101], v14 offset:10240
  ds_read_b64_tr_b16 v[102:103], v14 offset:10752
  s_waitcnt lgkmcnt(4)
  v_mfma_f32_32x32x16_bf16 v[64:79], v[108:111], v[140:143], v[64:79]
  ds_read_b64_tr_b16 v[104:105], v14 offset:12288
  ds_read_b64_tr_b16 v[106:107], v14 offset:12800
  s_waitcnt lgkmcnt(4)
  v_mfma_f32_32x32x16_bf16 v[64:79], v[96:99], v[144:147], v[64:79]
  ds_read_b64_tr_b16 v[108:109], v14 offset:14336
  ds_read_b64_tr_b16 v[110:111], v14 offset:14848
  s_waitcnt lgkmcnt(4)
  v_mfma_f32_32x32x16_bf16 v[64:79], v[100:103], v[148:151], v[64:79]
  ds_read_b64_tr_b16 v[96:97], v14 offset:16384
  ds_read_b64_tr_b16 v[98:99], v14 offset:16896
  s_waitcnt lgkmcnt(4)
  v_mfma_f32_32x32x16_bf16 v[64:79], v[104:107], v[152:155], v[64:79]
  ds_read_b64_tr_b16 v[100:101], v14 offset:18432
  ds_read_b64_tr_b16 v[102:103], v14 offset:18944
  s_waitcnt lgkmcnt(4)
  v_mfma_f32_32x32x16_bf16 v[64:79], v[108:111], v[156:159], v[64:79]
  ds_read_b64_tr_b16 v[104:105], v14 offset:20480
  ds_read_b64_tr_b16 v[106:107], v14 offset:20992
  s_waitcnt lgkmcnt(4)
  v_mfma_f32_32x32x16_bf16 v[64:79], v[96:99], v[160:163], v[64:79]
  ds_read_b64_tr_b16 v[108:109], v14 offset:22528
  ds_read_b64_tr_b16 v[110:111], v14 offset:23040
  s_waitcnt lgkmcnt(4)
  v_mfma_f32_32x32x16_bf16 v[64:79], v[100:103], v[164:167], v[64:79]
  ds_read_b64_tr_b16 v[96:97], v14 offset:24576
  ds_read_b64_tr_b16 v[98:99], v14 offset:25088
  s_waitcnt lgkmcnt(4)
  v_mfma_f32_32x32x16_bf16 v[64:79], v[104:107], v[168:171], v[64:79]
  ds_read_b64_tr_b16 v[100:101], v14 offset:26624
  ds_read_b64_tr_b16 v[102:103], v14 offset:27136
  s_waitcnt lgkmcnt(4)
  v_mfma_f32_32x32x16_bf16 v[64:79], v[108:111], v[172:175], v[64:79]
  ds_read_b64_tr_b16 v[104:105], v14 offset:28672
  ds_read_b64_tr_b16 v[106:107], v14 offset:29184
  s_waitcnt lgkmcnt(4)
  v_mfma_f32_32x32x16_bf16 v[64:79], v[96:99], v[176:179], v[64:79]
  ds_read_b64_tr_b16 v[108:109], v14 offset:30720
  ds_read_b64_tr_b16 v[110:111], v14 offset:31232
  s_waitcnt lgkmcnt(4)
  v_mfma_f32_32x32x16_bf16 v[64:79], v[100:103], v[180:183], v[64:79]
  ds_read_b64_tr_b16 v[96:97], v14 offset:32768
  ds_read_b64_tr_b16 v[98:99], v14 offset:33280
  s_waitcnt lgkmcnt(4)
  v_mfma_f32_32x32x16_bf16 v[64:79], v[104:107], v[184:187], v[64:79]
  ds_read_b64_tr_b16 v[100:101], v14 offset:34816
  ds_read_b64_tr_b16 v[102:103], v14 offset:35328
  s_waitcnt lgkmcnt(4)
  v_mfma_f32_32x32x16_bf16 v[64:79], v[108:111], v[188:191], v[64:79]
  ds_read_b64_tr_b16 v[104:105], v14 offset:36864
  ds_read_b64_tr_b16 v[106:107], v14 offset:37376
  s_waitcnt lgkmcnt(4)
  v_mfma_f32_32x32x16_bf16 v[64:79], v[96:99], v[192:195], v[64:79]
  ds_read_b64_tr_b16 v[108:109], v14 offset:38912
  ds_read_b64_tr_b16 v[110:111], v14 offset:39424
  s_waitcnt lgkmcnt(4)
  v_mfma_f32_32x32x16_bf16 v[64:79], v[100:103], v[196:199], v[64:79]
  ds_read_b64_tr_b16 v[96:97], v14 offset:40960
  ds_read_b64_tr_b16 v[98:99], v14 offset:41472
  s_waitcnt lgkmcnt(4)
  v_mfma_f32_32x32x16_bf16 v[64:79], v[104:107], v[200:203], v[64:79]
  ds_read_b64_tr_b16 v[100:101], v14 offset:43008
  ds_read_b64_tr_b16 v[102:103], v14 offset:43520
  s_waitcnt lgkmcnt(4)
  v_mfma_f32_32x32x16_bf16 v[64:79], v[108:111], v[204:207], v[64:79]
  ds_read_b64_tr_b16 v[104:105], v14 offset:45056
  ds_read_b64_tr_b16 v[106:107], v14 offset:45568
  s_waitcnt lgkmcnt(4)
  v_mfma_f32_32x32x16_bf16 v[64:79], v[96:99], v[208:211], v[64:79]
  ds_read_b64_tr_b16 v[108:109], v14 offset:47104
  ds_read_b64_tr_b16 v[110:111], v14 offset:47616
  s_waitcnt lgkmcnt(4)
  v_mfma_f32_32x32x16_bf16 v[64:79], v[100:103], v[212:215], v[64:79]
  ds_read_b64_tr_b16 v[96:97], v14 offset:49152
  ds_read_b64_tr_b16 v[98:99], v14 offset:49664
  s_waitcnt lgkmcnt(4)
  v_mfma_f32_32x32x16_bf16 v[64:79], v[104:107], v[216:219], v[64:79]
  ds_read_b64_tr_b16 v[100:101], v14 offset:51200
  ds_read_b64_tr_b16 v[102:103], v14 offset:51712
  s_waitcnt lgkmcnt(4)
  v_mfma_f32_32x32x16_bf16 v[64:79], v[108:111], v[220:223], v[64:79]
  ds_read_b64_tr_b16 v[104:105], v14 offset:53248
  ds_read_b64_tr_b16 v[106:107], v14 offset:53760
  s_waitcnt lgkmcnt(4)
  v_mfma_f32_32x32x16_bf16 v[64:79], v[96:99], v[224:227], v[64:79]
  ds_read_b64_tr_b16 v[108:109], v14 offset:55296
  ds_read_b64_tr_b16 v[110:111], v14 offset:55808
  s_waitcnt lgkmcnt(4)
  v_mfma_f32_32x32x16_bf16 v[64:79], v[100:103], v[228:231], v[64:79]
  ds_read_b64_tr_b16 v[96:97], v14 offset:57344
  ds_read_b64_tr_b16 v[98:99], v14 offset:57856
  s_waitcnt lgkmcnt(4)
  v_mfma_f32_32x32x16_bf16 v[64:79], v[104:107], v[232:235], v[64:79]
  ds_read_b64_tr_b16 v[100:101], v14 offset:59392
  ds_read_b64_tr_b16 v[102:103], v14 offset:59904
  s_waitcnt lgkmcnt(4)
  v_mfma_f32_32x32x16_bf16 v[64:79], v[108:111], v[236:239], v[64:79]
  ds_read_b64_tr_b16 v[104:105], v14 offset:61440
  ds_read_b64_tr_b16 v[106:107], v14 offset:61952
  s_waitcnt lgkmcnt(4)
  v_mfma_f32_32x32x16_bf16 v[64:79], v[96:99], v[240:243], v[64:79]
  ds_read_b64_tr_b16 v[108:109], v14 offset:63488
  ds_read_b64_tr_b16 v[110:111], v14 offset:64000
  s_waitcnt lgkmcnt(4)
  v_mfma_f32_32x32x16_bf16 v[64:79], v[100:103], v[244:247], v[64:79]
  s_waitcnt lgkmcnt(2)
  v_mfma_f32_32x32x16_bf16 v[64:79], v[104:107], v[248:251], v[64:79]
  s_waitcnt lgkmcnt(0)
  v_mfma_f32_32x32x16_bf16 v[64:79], v[108:111], v[252:255], v[64:79]
  v_lshrrev_b32 v24, 5, v0
  v_lshlrev_b32 v24, 4, v24
  v_add_u32 v24, 133632, v24
  ds_read_b128 v[32:35], v24 offset:0
  ds_read_b128 v[36:39], v24 offset:32
  ds_read_b128 v[40:43], v24 offset:64
  ds_read_b128 v[44:47], v24 offset:96
  v_lshrrev_b32 v25, 5, v0
  v_lshlrev_b32 v25, 4, v25
  v_add_u32 v25, 134656, v25
  ds_read_b128 v[48:51], v25 offset:0
  ds_read_b128 v[52:55], v25 offset:32
  ds_read_b128 v[56:59], v25 offset:64
  ds_read_b128 v[60:63], v25 offset:96
  s_mul_i32 s73, s62, 144
  s_lshr_b32 s74, s83, 4
  s_add_u32 s73, s73, s74
  s_lshl_b32 s73, s73, 10
  s_add_u32 s73, s73, 10485760
  s_waitcnt lgkmcnt(0)
  v_fma_f32 v64, v32, v18, v64
  v_fma_f32 v65, v33, v18, v65
  v_fma_f32 v66, v34, v18, v66
  v_fma_f32 v67, v35, v18, v67
  v_fma_f32 v68, v36, v18, v68
  v_fma_f32 v69, v37, v18, v69
  v_fma_f32 v70, v38, v18, v70
  v_fma_f32 v71, v39, v18, v71
  v_fma_f32 v72, v40, v18, v72
  v_fma_f32 v73, v41, v18, v73
  v_fma_f32 v74, v42, v18, v74
  v_fma_f32 v75, v43, v18, v75
  v_fma_f32 v76, v44, v18, v76
  v_fma_f32 v77, v45, v18, v77
  v_fma_f32 v78, v46, v18, v78
  v_fma_f32 v79, v47, v18, v79
  v_fma_f32 v64, v64, v19, v48
  v_fma_f32 v65, v65, v19, v49
  v_fma_f32 v66, v66, v19, v50
  v_fma_f32 v67, v67, v19, v51
  v_fma_f32 v68, v68, v19, v52
  v_fma_f32 v69, v69, v19, v53
  v_fma_f32 v70, v70, v19, v54
  v_fma_f32 v71, v71, v19, v55
  v_fma_f32 v72, v72, v19, v56
  v_fma_f32 v73, v73, v19, v57
  v_fma_f32 v74, v74, v19, v58
  v_fma_f32 v75, v75, v19, v59
  v_fma_f32 v76, v76, v19, v60
  v_fma_f32 v77, v77, v19, v61
  v_fma_f32 v78, v78, v19, v62
  v_fma_f32 v79, v79, v19, v63
  v_mul_f32 v32, 0x3fb8aa3b, v64
  v_mul_f32 v33, 0x3fb8aa3b, v65
  v_mul_f32 v34, 0x3fb8aa3b, v66
  v_mul_f32 v35, 0x3fb8aa3b, v67
  v_mul_f32 v36, 0x3fb8aa3b, v68
  v_mul_f32 v37, 0x3fb8aa3b, v69
  v_mul_f32 v38, 0x3fb8aa3b, v70
  v_mul_f32 v39, 0x3fb8aa3b, v71
  v_mul_f32 v40, 0x3fb8aa3b, v72
  v_mul_f32 v41, 0x3fb8aa3b, v73
  v_mul_f32 v42, 0x3fb8aa3b, v74
  v_mul_f32 v43, 0x3fb8aa3b, v75
  v_mul_f32 v44, 0x3fb8aa3b, v76
  v_mul_f32 v45, 0x3fb8aa3b, v77
  v_mul_f32 v46, 0x3fb8aa3b, v78
  v_mul_f32 v47, 0x3fb8aa3b, v79
  v_exp_f32 v32, v32
  v_exp_f32 v33, v33
  v_exp_f32 v34, v34
  v_exp_f32 v35, v35
  v_exp_f32 v36, v36
  v_exp_f32 v37, v37
  v_exp_f32 v38, v38
  v_exp_f32 v39, v39
  v_exp_f32 v40, v40
  v_exp_f32 v41, v41
  v_exp_f32 v42, v42
  v_exp_f32 v43, v43
  v_exp_f32 v44, v44
  v_exp_f32 v45, v45
  v_exp_f32 v46, v46
  v_exp_f32 v47, v47
  v_fma_f32 v48, 0.5, v32, 1.0
  v_fma_f32 v49, 0.5, v33, 1.0
  v_fma_f32 v50, 0.5, v34, 1.0
  v_fma_f32 v51, 0.5, v35, 1.0
  v_fma_f32 v52, 0.5, v36, 1.0
  v_fma_f32 v53, 0.5, v37, 1.0
  v_fma_f32 v54, 0.5, v38, 1.0
  v_fma_f32 v55, 0.5, v39, 1.0
  v_fma_f32 v56, 0.5, v40, 1.0
  v_fma_f32 v57, 0.5, v41, 1.0
  v_fma_f32 v58, 0.5, v42, 1.0
  v_fma_f32 v59, 0.5, v43, 1.0
  v_fma_f32 v60, 0.5, v44, 1.0
  v_fma_f32 v61, 0.5, v45, 1.0
  v_fma_f32 v62, 0.5, v46, 1.0
  v_fma_f32 v63, 0.5, v47, 1.0
  v_fma_f32 v48, v48, v32, 1.0
  v_fma_f32 v49, v49, v33, 1.0
  v_fma_f32 v50, v50, v34, 1.0
  v_fma_f32 v51, v51, v35, 1.0
  v_fma_f32 v52, v52, v36, 1.0
  v_fma_f32 v53, v53, v37, 1.0
  v_fma_f32 v54, v54, v38, 1.0
  v_fma_f32 v55, v55, v39, 1.0
  v_fma_f32 v56, v56, v40, 1.0
  v_fma_f32 v57, v57, v41, 1.0
  v_fma_f32 v58, v58, v42, 1.0
  v_fma_f32 v59, v59, v43, 1.0
  v_fma_f32 v60, v60, v44, 1.0
  v_fma_f32 v61, v61, v45, 1.0
  v_fma_f32 v62, v62, v46, 1.0
  v_fma_f32 v63, v63, v47, 1.0
  v_rcp_f32 v48, v48
  v_rcp_f32 v49, v49
  v_rcp_f32 v50, v50
  v_rcp_f32 v51, v51
  v_rcp_f32 v52, v52
  v_rcp_f32 v53, v53
  v_rcp_f32 v54, v54
  v_rcp_f32 v55, v55
  v_rcp_f32 v56, v56
  v_rcp_f32 v57, v57
  v_rcp_f32 v58, v58
  v_rcp_f32 v59, v59
  v_rcp_f32 v60, v60
  v_rcp_f32 v61, v61
  v_rcp_f32 v62, v62
  v_rcp_f32 v63, v63
  s_nop 0
  v_fma_f32 v64, -v64, v48, v64
  v_fma_f32 v65, -v65, v49, v65
  v_fma_f32 v66, -v66, v50, v66
  v_fma_f32 v67, -v67, v51, v67
  v_fma_f32 v68, -v68, v52, v68
  v_fma_f32 v69, -v69, v53, v69
  v_fma_f32 v70, -v70, v54, v70
  v_fma_f32 v71, -v71, v55, v71
  v_fma_f32 v72, -v72, v56, v72
  v_fma_f32 v73, -v73, v57, v73
  v_fma_f32 v74, -v74, v58, v74
  v_fma_f32 v75, -v75, v59, v75
  v_fma_f32 v76, -v76, v60, v76
  v_fma_f32 v77, -v77, v61, v77
  v_fma_f32 v78, -v78, v62, v78
  v_fma_f32 v79, -v79, v63, v79
  v_cvt_pk_bf16_f32 v64, v64, v65
  v_cvt_pk_bf16_f32 v65, v66, v67
  v_cvt_pk_bf16_f32 v66, v68, v69
  v_cvt_pk_bf16_f32 v67, v70, v71
  v_cvt_pk_bf16_f32 v68, v72, v73
  v_cvt_pk_bf16_f32 v69, v74, v75
  v_cvt_pk_bf16_f32 v70, v76, v77
  v_cvt_pk_bf16_f32 v71, v78, v79
  buffer_store_dwordx4 v[64:67], v16, s[20:23], s73 offen sc1
  buffer_store_dwordx4 v[68:71], v16, s[20:23], s73 offen offset:1024 sc1
  s_waitcnt vmcnt(2)
  v_lshrrev_b32 v24, 5, v0
  v_lshlrev_b32 v24, 9, v24
  s_add_u32 s73, s64, 71936
  v_sub_u32 v24, s73, v24
  v_add_u32 v25, v24, v15
  v_add_u32 v24, v24, v14
  s_xor_b32 s74, s64, 8192
  s_sub_u32 s74, s74, s64
  v_add_u32 v26, s74, v24
  v_add_u32 v27, s74, v25
  ds_read_b64_tr_b16 v[48:49], v24
  ds_read_b64_tr_b16 v[50:51], v24 offset:1024
  ds_read_b64_tr_b16 v[52:53], v25
  ds_read_b64_tr_b16 v[54:55], v25 offset:1024
  ds_read_b64_tr_b16 v[56:57], v26
  ds_read_b64_tr_b16 v[58:59], v26 offset:1024
  ds_read_b64_tr_b16 v[60:61], v27
  ds_read_b64_tr_b16 v[62:63], v27 offset:1024
  s_add_u32 s73, s80, 147456
  s_add_u32 s74, s33, 147456
  s_waitcnt lgkmcnt(0)
  buffer_store_dwordx4 v[48:51], v16, s[20:23], s80 offen sc1
  buffer_store_dwordx4 v[52:55], v16, s[20:23], s73 offen sc1
  buffer_store_dwordx4 v[56:59], v16, s[20:23], s33 offen sc1
  buffer_store_dwordx4 v[60:63], v16, s[20:23], s74 offen sc1
  s_cmp_eq_u32 s57, 1
  s_cbranch_scc0 k1_f1d2
  s_and_b32 s73, s2, 31
  s_lshr_b32 s73, s73, 2
  s_lshl_b32 s73, s73, 7
  s_add_u32 s73, s73, 20975616
  v_and_b32 v24, 31, v0
  v_lshlrev_b32 v24, 2, v24
  s_mov_b32 s77, 0
k1_f1p2:
  buffer_load_dword v25, v24, s[20:23], s73 offen sc1
  s_waitcnt vmcnt(0)
  v_cmp_eq_u32 vcc, s90, v25
  s_add_u32 s77, s77, 1
  s_cmp_gt_u32 s77, 200000
  s_cbranch_scc1 k1_f1d2
  s_cmp_eq_u64 vcc, exec
  s_cbranch_scc0 k1_f1p2
k1_f1d2:
  s_waitcnt lgkmcnt(0)
  s_barrier
  s_branch k1_phase2
k1_phase2:
  s_mov_b64 s[4:5], s[54:55]
  s_mov_b64 s[6:7], s[36:37]
  s_mov_b64 s[40:41], s[50:51]
  s_mov_b64 s[42:43], s[52:53]
  s_mov_b32 s14, s56
  s_mov_b32 s36, s90
  s_lshl_b32 s17, s56, 6
  v_add_u32 v244, s17, v0
  s_lshl_b32 s91, s59, 7
  s_lshl_b32 s17, s60, 1
  s_add_u32 s17, s17, s61
  s_lshl_b32 s17, s17, 2
  s_add_u32 s91, s91, s17
  s_add_u32 s91, s91, 20983808
  s_and_b32 s12, s2, 31
  s_lshr_b32 s13, s2, 5
  v_lshlrev_b32 v107, 4, v0
  s_lshr_b32 s16, s14, 2
  s_and_b32 s17, s14, 3
  s_lshl_b32 s19, s17, 12
  s_lshl_b32 s20, s16, 16
  s_add_u32 s22, s19, s20
  s_mov_b32 m0, s22
  s_lshl_b32 s24, s12, 16
  s_lshl_b32 s23, s16, 21
  s_add_u32 s23, s23, s24
  s_add_u32 s23, s23, 2097152
  s_add_u32 s25, s23, s19
  s_lshl_b32 s26, s13, 3
  s_lshl_b32 s27, s17, 1
  s_add_u32 s26, s26, s27
  s_lshl_b32 s27, s26, 10
  s_add_u32 s27, s27, s24
  s_add_u32 s27, s27, 0
  s_waitcnt lgkmcnt(0)
  s_mov_b32 s8, s4
  s_and_b32 s9, s5, 0xffff
  s_mov_b32 s10, 268435456
  s_mov_b32 s11, 0x00020000
  v_lshlrev_b32 v1, 2, v0
  s_lshr_b32 s28, s12, 2
  s_lshl_b32 s28, s28, 8
  s_add_u32 s28, s28, 6291456
  buffer_load_dword v2, v1, s[8:11], s28 offen sc1
  buffer_load_dword v3, v1, s[8:11], s28 offen offset:2048 sc1
  s_add_u32 s28, s28, 4096
  buffer_load_dword v4, v1, s[8:11], s28 offen sc1
  buffer_load_dwordx4 v107, s[8:11], s25 offen offset:0 sc1 lds
  buffer_load_dwordx4 v107, s[8:11], s25 offen offset:1024 sc1 lds
  buffer_load_dwordx4 v107, s[8:11], s25 offen offset:2048 sc1 lds
  buffer_load_dwordx4 v107, s[8:11], s25 offen offset:3072 sc1 lds
  s_mov_b32 s52, s42
  s_and_b32 s53, s43, 0xffff
  s_mov_b32 s54, 256
  s_mov_b32 s55, 0x00020000
  s_mov_b32 s44, s6
  s_and_b32 s45, s7, 0xffff
  s_mov_b32 s46, 2097152
  s_mov_b32 s47, 0x00020000
  s_mov_b32 s48, s40
  s_and_b32 s49, s41, 0xffff
  s_mov_b32 s50, 2097152
  s_mov_b32 s51, 0x00020000
  s_cmp_lt_u32 s14, 4
  s_cbranch_scc0 att_gem
  buffer_load_dwordx4 v[8:11], v107, s[8:11], s27 offen sc1
  buffer_load_dwordx4 v[12:15], v107, s[8:11], s27 offen offset:1024 sc1
  v_and_b32 v5, 15, v0
  v_cmp_eq_u32 vcc, 0, v5
  v_mov_b32 v6, 0x3f803f80
  v_mov_b32 v7, 0
  v_cndmask_b32 v108, v7, v6, vcc
  v_cndmask_b32 v109, v7, v6, vcc
  v_cndmask_b32 v110, v7, v6, vcc
  v_cndmask_b32 v111, v7, v6, vcc
  s_mul_i32 s30, s14, 3072
  s_add_u32 s30, s30, 131072
  v_add_u32 v5, s30, v107
  ds_write_b128 v5, v[108:111]
  ds_write_b128 v5, v[108:111] offset:1024
  ds_write_b128 v5, v[108:111] offset:2048
  v_mov_b32 v5, 143360
  ds_write_b32 v5, v7
  ds_write_b32 v5, v7 offset:4
  ds_write_b32 v5, v7 offset:8
  v_mov_b32 v104, v107
  v_and_b32 v5, 31, v0
  v_lshrrev_b32 v6, 5, v0
  v_lshlrev_b32 v7, 4, v5
  v_lshl_add_u32 v7, v6, 8, v7
  v_add_u32 v7, 65536, v7
  v_subrev_u32 v6, 20, v5
  v_cmp_gt_u32 vcc, 8, v6
  v_mov_b32 v105, 131088
  v_mov_b32 v6, 131136
  v_cndmask_b32 v105, v105, v6, vcc
  v_cmp_eq_u32 vcc, 16, v5
  v_mov_b32 v6, 131072
  s_nop 0
  v_cndmask_b32 v105, v105, v6, vcc
  v_cmp_gt_u32 vcc, 16, v5
  v_mov_b32 v106, 0
  v_mov_b32 v6, 8192
  v_cndmask_b32 v105, v105, v7, vcc
  v_cndmask_b32 v106, v106, v6, vcc
  v_mov_b32 v48, 0
  v_mov_b32 v49, 0
  v_mov_b32 v50, 0
  v_mov_b32 v51, 0
  v_mov_b32 v52, 0
  v_mov_b32 v53, 0
  v_mov_b32 v54, 0
  v_mov_b32 v55, 0
  v_mov_b32 v56, 0
  v_mov_b32 v57, 0
  v_mov_b32 v58, 0
  v_mov_b32 v59, 0
  v_mov_b32 v60, 0
  v_mov_b32 v61, 0
  v_mov_b32 v62, 0
  v_mov_b32 v63, 0
  v_mov_b32 v64, 0
  v_mov_b32 v65, 0
  v_mov_b32 v66, 0
  v_mov_b32 v67, 0
  v_mov_b32 v68, 0
  v_mov_b32 v69, 0
  v_mov_b32 v70, 0
  v_mov_b32 v71, 0
  v_mov_b32 v72, 0
  v_mov_b32 v73, 0
  v_mov_b32 v74, 0
  v_mov_b32 v75, 0
  v_mov_b32 v76, 0
  v_mov_b32 v77, 0
  v_mov_b32 v78, 0
  v_mov_b32 v79, 0
  v_mov_b32 v36, 0
  v_mov_b32 v37, 0
  v_mov_b32 v38, 0
  v_mov_b32 v39, 0
  v_mov_b32 v46, 0
  v_mov_b32 v47, 0
  v_mov_b32 v100, 0
  v_mov_b32 v101, 0
  v_mov_b32 v102, 0
  v_mov_b32 v103, 0
  s_waitcnt vmcnt(6)
  s_nop 1
  v_max_f32_dpp v2, v2, v2 row_ror:8 row_mask:0xf bank_mask:0xf
  s_nop 1
  v_max_f32_dpp v2, v2, v2 row_ror:4 row_mask:0xf bank_mask:0xf
  s_nop 1
  v_max_f32_dpp v2, v2, v2 row_ror:2 row_mask:0xf bank_mask:0xf
  s_nop 1
  v_max_f32_dpp v2, v2, v2 row_ror:1 row_mask:0xf bank_mask:0xf
  v_mov_b32 v5, v2
  s_nop 1
  v_permlane16_swap_b32 v2, v5
  s_nop 1
  v_max_f32 v2, v2, v5
  v_mov_b32 v5, v2
  s_nop 1
  v_permlane32_swap_b32 v2, v5
  s_nop 1
  v_max_f32 v2, v2, v5
  s_nop 1
  v_max_f32_dpp v3, v3, v3 row_ror:8 row_mask:0xf bank_mask:0xf
  s_nop 1
  v_max_f32_dpp v3, v3, v3 row_ror:4 row_mask:0xf bank_mask:0xf
  s_nop 1
  v_max_f32_dpp v3, v3, v3 row_ror:2 row_mask:0xf bank_mask:0xf
  s_nop 1
  v_max_f32_dpp v3, v3, v3 row_ror:1 row_mask:0xf bank_mask:0xf
  v_mov_b32 v5, v3
  s_nop 1
  v_permlane16_swap_b32 v3, v5
  s_nop 1
  v_max_f32 v3, v3, v5
  v_mov_b32 v5, v3
  s_nop 1
  v_permlane32_swap_b32 v3, v5
  s_nop 1
  v_max_f32 v3, v3, v5
  s_nop 1
  v_max_f32_dpp v4, v4, v4 row_ror:8 row_mask:0xf bank_mask:0xf
  s_nop 1
  v_max_f32_dpp v4, v4, v4 row_ror:4 row_mask:0xf bank_mask:0xf
  s_nop 1
  v_max_f32_dpp v4, v4, v4 row_ror:2 row_mask:0xf bank_mask:0xf
  s_nop 1
  v_max_f32_dpp v4, v4, v4 row_ror:1 row_mask:0xf bank_mask:0xf
  v_mov_b32 v5, v4
  s_nop 1
  v_permlane16_swap_b32 v4, v5
  s_nop 1
  v_max_f32 v4, v4, v5
  v_mov_b32 v5, v4
  s_nop 1
  v_permlane32_swap_b32 v4, v5
  s_nop 1
  v_max_f32 v4, v4, v5
  v_mul_f32 v2, v2, v3
  v_mov_b32 v5, 1148190720
  v_mov_b32 v6, 0x53800000
  v_cmp_le_f32 vcc, v2, v5
  v_cmp_le_f32 s[30:31], v4, v6
  s_nop 4
  s_and_b64 s[30:31], vcc, s[30:31]
  s_waitcnt vmcnt(0) lgkmcnt(0)
  s_barrier
  ds_read_b128 v[80:83], v104
  ds_read_b128 v[88:91], v105
  ds_read_b128 v[92:95], v105 offset:512
  s_cmp_eq_u64 s[30:31], exec
  s_waitcnt lgkmcnt(0)
  s_cbranch_scc0 att_slow
  v_mfma_f32_32x32x16_bf16 v[16:31], v[80:83], v[8:11], 0
  s_nop 7
  s_nop 3
  s_mov_b32 s21, 0
  .p2align 6
att_f_loop:
  s_bitcmp1_b32 0xa, s21
  s_cbranch_scc1 att_f_bar
att_f_nobar:
  v_exp_f32 v16, v16
  v_cvt_pk_bf16_f32 v39, v46, v47
  v_exp_f32 v17, v17
  v_exp_f32 v18, v18
  v_mfma_f32_32x32x16_bf16 v[64:79], v[100:103], v[36:39], v[64:79]
  ds_read_b128 v[84:87], v104 offset:1024
  v_cvt_pk_bf16_f32 v16, v16, v17
  v_exp_f32 v19, v19
  v_exp_f32 v20, v20
  v_cvt_pk_bf16_f32 v17, v18, v19
  v_exp_f32 v21, v21
  v_exp_f32 v22, v22
  v_mfma_f32_32x32x16_bf16 v[32:47], v[80:83], v[12:15], 0
  ds_read_b128 v[96:99], v105 offset:1024
  v_cvt_pk_bf16_f32 v18, v20, v21
  v_exp_f32 v23, v23
  v_exp_f32 v24, v24
  v_cvt_pk_bf16_f32 v19, v22, v23
  v_exp_f32 v25, v25
  v_exp_f32 v26, v26
  v_mfma_f32_32x32x16_bf16 v[48:63], v[88:91], v[16:19], v[48:63]
  ds_read_b128 v[100:103], v105 offset:1536
  v_cvt_pk_bf16_f32 v20, v24, v25
  v_exp_f32 v27, v27
  v_exp_f32 v28, v28
  v_cvt_pk_bf16_f32 v21, v26, v27
  v_exp_f32 v29, v29
  v_exp_f32 v30, v30
  v_cvt_pk_bf16_f32 v22, v28, v29
  v_exp_f32 v31, v31
  v_exp_f32 v32, v32
  v_cvt_pk_bf16_f32 v23, v30, v31
  v_exp_f32 v33, v33
  v_exp_f32 v34, v34
  v_mfma_f32_32x32x16_bf16 v[48:63], v[92:95], v[20:23], v[48:63]
  s_waitcnt lgkmcnt(0)
  v_cvt_pk_bf16_f32 v32, v32, v33
  v_exp_f32 v35, v35
  v_exp_f32 v36, v36
  v_cvt_pk_bf16_f32 v33, v34, v35
  v_exp_f32 v37, v37
  v_exp_f32 v38, v38
  v_mfma_f32_32x32x16_bf16 v[16:31], v[84:87], v[8:11], 0
  v_cvt_pk_bf16_f32 v34, v36, v37
  v_exp_f32 v39, v39
  v_exp_f32 v40, v40
  v_cvt_pk_bf16_f32 v35, v38, v39
  v_exp_f32 v41, v41
  v_exp_f32 v42, v42
  v_mfma_f32_32x32x16_bf16 v[64:79], v[88:91], v[32:35], v[64:79]
  v_cvt_pk_bf16_f32 v36, v40, v41
  v_exp_f32 v43, v43
  v_exp_f32 v44, v44
  v_cvt_pk_bf16_f32 v37, v42, v43
  v_exp_f32 v45, v45
  v_exp_f32 v46, v46
  v_cvt_pk_bf16_f32 v38, v44, v45
  v_exp_f32 v47, v47
  v_exp_f32 v16, v16
  v_cvt_pk_bf16_f32 v39, v46, v47
  v_exp_f32 v17, v17
  v_exp_f32 v18, v18
  v_mfma_f32_32x32x16_bf16 v[64:79], v[92:95], v[36:39], v[64:79]
  ds_read_b128 v[80:83], v104 offset:2048
  v_cvt_pk_bf16_f32 v16, v16, v17
  v_exp_f32 v19, v19
  v_exp_f32 v20, v20
  v_cvt_pk_bf16_f32 v17, v18, v19
  v_exp_f32 v21, v21
  v_exp_f32 v22, v22
  v_mfma_f32_32x32x16_bf16 v[32:47], v[84:87], v[12:15], 0
  ds_read_b128 v[88:91], v105 offset:2048
  v_cvt_pk_bf16_f32 v18, v20, v21
  v_exp_f32 v23, v23
  v_exp_f32 v24, v24
  v_cvt_pk_bf16_f32 v19, v22, v23
  v_exp_f32 v25, v25
  v_exp_f32 v26, v26
  v_mfma_f32_32x32x16_bf16 v[48:63], v[96:99], v[16:19], v[48:63]
  ds_read_b128 v[92:95], v105 offset:2560
  v_cvt_pk_bf16_f32 v20, v24, v25
  v_exp_f32 v27, v27
  v_exp_f32 v28, v28
  v_cvt_pk_bf16_f32 v21, v26, v27
  v_exp_f32 v29, v29
  v_exp_f32 v30, v30
  v_cvt_pk_bf16_f32 v22, v28, v29
  v_exp_f32 v31, v31
  v_exp_f32 v32, v32
  v_cvt_pk_bf16_f32 v23, v30, v31
  v_exp_f32 v33, v33
  v_exp_f32 v34, v34
  v_mfma_f32_32x32x16_bf16 v[48:63], v[100:103], v[20:23], v[48:63]
  s_waitcnt lgkmcnt(0)
  v_cvt_pk_bf16_f32 v32, v32, v33
  v_exp_f32 v35, v35
  v_exp_f32 v36, v36
  v_cvt_pk_bf16_f32 v33, v34, v35
  v_exp_f32 v37, v37
  v_exp_f32 v38, v38
  v_mfma_f32_32x32x16_bf16 v[16:31], v[80:83], v[8:11], 0
  v_cvt_pk_bf16_f32 v34, v36, v37
  v_exp_f32 v39, v39
  v_exp_f32 v40, v40
  v_cvt_pk_bf16_f32 v35, v38, v39
  v_exp_f32 v41, v41
  v_exp_f32 v42, v42
  v_mfma_f32_32x32x16_bf16 v[64:79], v[96:99], v[32:35], v[64:79]
  v_cvt_pk_bf16_f32 v36, v40, v41
  v_exp_f32 v43, v43
  v_exp_f32 v44, v44
  v_cvt_pk_bf16_f32 v37, v42, v43
  v_exp_f32 v45, v45
  v_exp_f32 v46, v46
  v_cvt_pk_bf16_f32 v38, v44, v45
  v_exp_f32 v47, v47
  v_exp_f32 v16, v16
  v_cvt_pk_bf16_f32 v39, v46, v47
  v_exp_f32 v17, v17
  v_exp_f32 v18, v18
  v_mfma_f32_32x32x16_bf16 v[64:79], v[100:103], v[36:39], v[64:79]
  ds_read_b128 v[84:87], v104 offset:3072
  v_cvt_pk_bf16_f32 v16, v16, v17
  v_exp_f32 v19, v19
  v_exp_f32 v20, v20
  v_cvt_pk_bf16_f32 v17, v18, v19
  v_exp_f32 v21, v21
  v_exp_f32 v22, v22
  v_mfma_f32_32x32x16_bf16 v[32:47], v[80:83], v[12:15], 0
  ds_read_b128 v[96:99], v105 offset:3072
  v_cvt_pk_bf16_f32 v18, v20, v21
  v_exp_f32 v23, v23
  v_exp_f32 v24, v24
  v_cvt_pk_bf16_f32 v19, v22, v23
  v_exp_f32 v25, v25
  v_exp_f32 v26, v26
  v_mfma_f32_32x32x16_bf16 v[48:63], v[88:91], v[16:19], v[48:63]
  ds_read_b128 v[100:103], v105 offset:3584
  v_cvt_pk_bf16_f32 v20, v24, v25
  v_exp_f32 v27, v27
  v_exp_f32 v28, v28
  v_cvt_pk_bf16_f32 v21, v26, v27
  v_exp_f32 v29, v29
  v_exp_f32 v30, v30
  v_cvt_pk_bf16_f32 v22, v28, v29
  v_exp_f32 v31, v31
  v_exp_f32 v32, v32
  v_cvt_pk_bf16_f32 v23, v30, v31
  v_exp_f32 v33, v33
  v_exp_f32 v34, v34
  v_mfma_f32_32x32x16_bf16 v[48:63], v[92:95], v[20:23], v[48:63]
  s_waitcnt lgkmcnt(0)
  v_cvt_pk_bf16_f32 v32, v32, v33
  v_exp_f32 v35, v35
  v_exp_f32 v36, v36
  v_cvt_pk_bf16_f32 v33, v34, v35
  v_exp_f32 v37, v37
  v_exp_f32 v38, v38
  v_mfma_f32_32x32x16_bf16 v[16:31], v[84:87], v[8:11], 0
  v_cvt_pk_bf16_f32 v34, v36, v37
  v_exp_f32 v39, v39
  v_exp_f32 v40, v40
  v_cvt_pk_bf16_f32 v35, v38, v39
  v_exp_f32 v41, v41
  v_exp_f32 v42, v42
  v_mfma_f32_32x32x16_bf16 v[64:79], v[88:91], v[32:35], v[64:79]
  v_cvt_pk_bf16_f32 v36, v40, v41
  v_exp_f32 v43, v43
  v_exp_f32 v44, v44
  v_cvt_pk_bf16_f32 v37, v42, v43
  v_exp_f32 v45, v45
  v_exp_f32 v46, v46
  v_cvt_pk_bf16_f32 v38, v44, v45
  v_exp_f32 v47, v47
  v_exp_f32 v16, v16
  v_cvt_pk_bf16_f32 v39, v46, v47
  v_exp_f32 v17, v17
  v_exp_f32 v18, v18
  v_mfma_f32_32x32x16_bf16 v[64:79], v[92:95], v[36:39], v[64:79]
  ds_read_b128 v[80:83], v104 offset:4096
  v_cvt_pk_bf16_f32 v16, v16, v17
  v_exp_f32 v19, v19
  v_exp_f32 v20, v20
  v_cvt_pk_bf16_f32 v17, v18, v19
  v_exp_f32 v21, v21
  v_exp_f32 v22, v22
  v_mfma_f32_32x32x16_bf16 v[32:47], v[84:87], v[12:15], 0
  ds_read_b128 v[88:91], v105 offset:4096
  v_cvt_pk_bf16_f32 v18, v20, v21
  v_exp_f32 v23, v23
  v_exp_f32 v24, v24
  v_cvt_pk_bf16_f32 v19, v22, v23
  v_exp_f32 v25, v25
  v_exp_f32 v26, v26
  v_mfma_f32_32x32x16_bf16 v[48:63], v[96:99], v[16:19], v[48:63]
  ds_read_b128 v[92:95], v105 offset:4608
  v_cvt_pk_bf16_f32 v20, v24, v25
  v_exp_f32 v27, v27
  v_exp_f32 v28, v28
  v_cvt_pk_bf16_f32 v21, v26, v27
  v_exp_f32 v29, v29
  v_exp_f32 v30, v30
  v_cvt_pk_bf16_f32 v22, v28, v29
  v_exp_f32 v31, v31
  v_exp_f32 v32, v32
  v_cvt_pk_bf16_f32 v23, v30, v31
  v_exp_f32 v33, v33
  v_exp_f32 v34, v34
  v_mfma_f32_32x32x16_bf16 v[48:63], v[100:103], v[20:23], v[48:63]
  s_waitcnt lgkmcnt(0)
  v_cvt_pk_bf16_f32 v32, v32, v33
  v_exp_f32 v35, v35
  v_exp_f32 v36, v36
  v_cvt_pk_bf16_f32 v33, v34, v35
  v_exp_f32 v37, v37
  v_exp_f32 v38, v38
  v_mfma_f32_32x32x16_bf16 v[16:31], v[80:83], v[8:11], 0
  v_cvt_pk_bf16_f32 v34, v36, v37
  v_exp_f32 v39, v39
  v_exp_f32 v40, v40
  v_cvt_pk_bf16_f32 v35, v38, v39
  v_exp_f32 v41, v41
  v_exp_f32 v42, v42
  v_mfma_f32_32x32x16_bf16 v[64:79], v[96:99], v[32:35], v[64:79]
  v_cvt_pk_bf16_f32 v36, v40, v41
  v_exp_f32 v43, v43
  v_exp_f32 v44, v44
  v_cvt_pk_bf16_f32 v37, v42, v43
  v_exp_f32 v45, v45
  v_exp_f32 v46, v46
  v_cvt_pk_bf16_f32 v38, v44, v45
  v_exp_f32 v47, v47
  v_exp_f32 v16, v16
  v_cvt_pk_bf16_f32 v39, v46, v47
  v_exp_f32 v17, v17
  v_exp_f32 v18, v18
  v_mfma_f32_32x32x16_bf16 v[64:79], v[100:103], v[36:39], v[64:79]
  ds_read_b128 v[84:87], v104 offset:5120
  v_cvt_pk_bf16_f32 v16, v16, v17
  v_exp_f32 v19, v19
  v_exp_f32 v20, v20
  v_cvt_pk_bf16_f32 v17, v18, v19
  v_exp_f32 v21, v21
  v_exp_f32 v22, v22
  v_mfma_f32_32x32x16_bf16 v[32:47], v[80:83], v[12:15], 0
  ds_read_b128 v[96:99], v105 offset:5120
  v_cvt_pk_bf16_f32 v18, v20, v21
  v_exp_f32 v23, v23
  v_exp_f32 v24, v24
  v_cvt_pk_bf16_f32 v19, v22, v23
  v_exp_f32 v25, v25
  v_exp_f32 v26, v26
  v_mfma_f32_32x32x16_bf16 v[48:63], v[88:91], v[16:19], v[48:63]
  ds_read_b128 v[100:103], v105 offset:5632
  v_cvt_pk_bf16_f32 v20, v24, v25
  v_exp_f32 v27, v27
  v_exp_f32 v28, v28
  v_cvt_pk_bf16_f32 v21, v26, v27
  v_exp_f32 v29, v29
  v_exp_f32 v30, v30
  v_cvt_pk_bf16_f32 v22, v28, v29
  v_exp_f32 v31, v31
  v_exp_f32 v32, v32
  v_cvt_pk_bf16_f32 v23, v30, v31
  v_exp_f32 v33, v33
  v_exp_f32 v34, v34
  v_mfma_f32_32x32x16_bf16 v[48:63], v[92:95], v[20:23], v[48:63]
  s_waitcnt lgkmcnt(0)
  v_cvt_pk_bf16_f32 v32, v32, v33
  v_exp_f32 v35, v35
  v_exp_f32 v36, v36
  v_cvt_pk_bf16_f32 v33, v34, v35
  v_exp_f32 v37, v37
  v_exp_f32 v38, v38
  v_mfma_f32_32x32x16_bf16 v[16:31], v[84:87], v[8:11], 0
  v_cvt_pk_bf16_f32 v34, v36, v37
  v_exp_f32 v39, v39
  v_exp_f32 v40, v40
  v_cvt_pk_bf16_f32 v35, v38, v39
  v_exp_f32 v41, v41
  v_exp_f32 v42, v42
  v_mfma_f32_32x32x16_bf16 v[64:79], v[88:91], v[32:35], v[64:79]
  v_cvt_pk_bf16_f32 v36, v40, v41
  v_exp_f32 v43, v43
  v_exp_f32 v44, v44
  v_cvt_pk_bf16_f32 v37, v42, v43
  v_exp_f32 v45, v45
  v_exp_f32 v46, v46
  v_cvt_pk_bf16_f32 v38, v44, v45
  v_exp_f32 v47, v47
  v_exp_f32 v16, v16
  v_cvt_pk_bf16_f32 v39, v46, v47
  v_exp_f32 v17, v17
  v_exp_f32 v18, v18
  v_mfma_f32_32x32x16_bf16 v[64:79], v[92:95], v[36:39], v[64:79]
  ds_read_b128 v[80:83], v104 offset:6144
  v_cvt_pk_bf16_f32 v16, v16, v17
  v_exp_f32 v19, v19
  v_exp_f32 v20, v20
  v_cvt_pk_bf16_f32 v17, v18, v19
  v_exp_f32 v21, v21
  v_exp_f32 v22, v22
  v_mfma_f32_32x32x16_bf16 v[32:47], v[84:87], v[12:15], 0
  ds_read_b128 v[88:91], v105 offset:6144
  v_cvt_pk_bf16_f32 v18, v20, v21
  v_exp_f32 v23, v23
  v_exp_f32 v24, v24
  v_cvt_pk_bf16_f32 v19, v22, v23
  v_exp_f32 v25, v25
  v_exp_f32 v26, v26
  v_mfma_f32_32x32x16_bf16 v[48:63], v[96:99], v[16:19], v[48:63]
  ds_read_b128 v[92:95], v105 offset:6656
  v_cvt_pk_bf16_f32 v20, v24, v25
  v_exp_f32 v27, v27
  v_exp_f32 v28, v28
  v_cvt_pk_bf16_f32 v21, v26, v27
  v_exp_f32 v29, v29
  v_exp_f32 v30, v30
  v_cvt_pk_bf16_f32 v22, v28, v29
  v_exp_f32 v31, v31
  v_exp_f32 v32, v32
  v_cvt_pk_bf16_f32 v23, v30, v31
  v_exp_f32 v33, v33
  v_exp_f32 v34, v34
  v_mfma_f32_32x32x16_bf16 v[48:63], v[100:103], v[20:23], v[48:63]
  s_waitcnt lgkmcnt(0)
  v_cvt_pk_bf16_f32 v32, v32, v33
  v_exp_f32 v35, v35
  v_exp_f32 v36, v36
  v_cvt_pk_bf16_f32 v33, v34, v35
  v_exp_f32 v37, v37
  v_exp_f32 v38, v38
  v_mfma_f32_32x32x16_bf16 v[16:31], v[80:83], v[8:11], 0
  v_cvt_pk_bf16_f32 v34, v36, v37
  v_exp_f32 v39, v39
  v_exp_f32 v40, v40
  v_cvt_pk_bf16_f32 v35, v38, v39
  v_exp_f32 v41, v41
  v_exp_f32 v42, v42
  v_mfma_f32_32x32x16_bf16 v[64:79], v[96:99], v[32:35], v[64:79]
  v_cvt_pk_bf16_f32 v36, v40, v41
  v_exp_f32 v43, v43
  v_exp_f32 v44, v44
  v_cvt_pk_bf16_f32 v37, v42, v43
  v_exp_f32 v45, v45
  v_exp_f32 v46, v46
  v_cvt_pk_bf16_f32 v38, v44, v45
  v_exp_f32 v47, v47
  v_exp_f32 v16, v16
  v_cvt_pk_bf16_f32 v39, v46, v47
  v_exp_f32 v17, v17
  v_exp_f32 v18, v18
  v_mfma_f32_32x32x16_bf16 v[64:79], v[100:103], v[36:39], v[64:79]
  ds_read_b128 v[84:87], v104 offset:7168
  v_cvt_pk_bf16_f32 v16, v16, v17
  v_exp_f32 v19, v19
  v_exp_f32 v20, v20
  v_cvt_pk_bf16_f32 v17, v18, v19
  v_exp_f32 v21, v21
  v_exp_f32 v22, v22
  v_mfma_f32_32x32x16_bf16 v[32:47], v[80:83], v[12:15], 0
  ds_read_b128 v[96:99], v105 offset:7168
  v_cvt_pk_bf16_f32 v18, v20, v21
  v_exp_f32 v23, v23
  v_exp_f32 v24, v24
  v_cvt_pk_bf16_f32 v19, v22, v23
  v_exp_f32 v25, v25
  v_exp_f32 v26, v26
  v_mfma_f32_32x32x16_bf16 v[48:63], v[88:91], v[16:19], v[48:63]
  ds_read_b128 v[100:103], v105 offset:7680
  v_cvt_pk_bf16_f32 v20, v24, v25
  v_exp_f32 v27, v27
  v_exp_f32 v28, v28
  v_cvt_pk_bf16_f32 v21, v26, v27
  v_exp_f32 v29, v29
  v_exp_f32 v30, v30
  v_cvt_pk_bf16_f32 v22, v28, v29
  v_exp_f32 v31, v31
  v_exp_f32 v32, v32
  v_cvt_pk_bf16_f32 v23, v30, v31
  v_exp_f32 v33, v33
  v_exp_f32 v34, v34
  v_mfma_f32_32x32x16_bf16 v[48:63], v[92:95], v[20:23], v[48:63]
  s_waitcnt lgkmcnt(0)
  v_cvt_pk_bf16_f32 v32, v32, v33
  v_exp_f32 v35, v35
  v_exp_f32 v36, v36
  v_cvt_pk_bf16_f32 v33, v34, v35
  v_exp_f32 v37, v37
  v_exp_f32 v38, v38
  v_mfma_f32_32x32x16_bf16 v[16:31], v[84:87], v[8:11], 0
  v_cvt_pk_bf16_f32 v34, v36, v37
  v_exp_f32 v39, v39
  v_exp_f32 v40, v40
  v_cvt_pk_bf16_f32 v35, v38, v39
  v_exp_f32 v41, v41
  v_exp_f32 v42, v42
  v_mfma_f32_32x32x16_bf16 v[64:79], v[88:91], v[32:35], v[64:79]
  v_cvt_pk_bf16_f32 v36, v40, v41
  v_exp_f32 v43, v43
  v_exp_f32 v44, v44
  v_cvt_pk_bf16_f32 v37, v42, v43
  v_exp_f32 v45, v45
  v_exp_f32 v46, v46
  v_cvt_pk_bf16_f32 v38, v44, v45
  v_exp_f32 v47, v47
  v_exp_f32 v16, v16
  v_cvt_pk_bf16_f32 v39, v46, v47
  v_exp_f32 v17, v17
  v_exp_f32 v18, v18
  v_mfma_f32_32x32x16_bf16 v[64:79], v[92:95], v[36:39], v[64:79]
  ds_read_b128 v[80:83], v104 offset:8192
  v_cvt_pk_bf16_f32 v16, v16, v17
  v_exp_f32 v19, v19
  v_exp_f32 v20, v20
  v_cvt_pk_bf16_f32 v17, v18, v19
  v_exp_f32 v21, v21
  v_exp_f32 v22, v22
  v_mfma_f32_32x32x16_bf16 v[32:47], v[84:87], v[12:15], 0
  ds_read_b128 v[88:91], v105 offset:8192
  v_cvt_pk_bf16_f32 v18, v20, v21
  v_exp_f32 v23, v23
  v_exp_f32 v24, v24
  v_cvt_pk_bf16_f32 v19, v22, v23
  v_exp_f32 v25, v25
  v_exp_f32 v26, v26
  v_mfma_f32_32x32x16_bf16 v[48:63], v[96:99], v[16:19], v[48:63]
  ds_read_b128 v[92:95], v105 offset:8704
  v_cvt_pk_bf16_f32 v20, v24, v25
  v_exp_f32 v27, v27
  v_exp_f32 v28, v28
  v_cvt_pk_bf16_f32 v21, v26, v27
  v_exp_f32 v29, v29
  v_exp_f32 v30, v30
  v_cvt_pk_bf16_f32 v22, v28, v29
  v_exp_f32 v31, v31
  v_exp_f32 v32, v32
  v_cvt_pk_bf16_f32 v23, v30, v31
  v_exp_f32 v33, v33
  v_exp_f32 v34, v34
  v_mfma_f32_32x32x16_bf16 v[48:63], v[100:103], v[20:23], v[48:63]
  s_waitcnt lgkmcnt(0)
  v_cvt_pk_bf16_f32 v32, v32, v33
  v_exp_f32 v35, v35
  v_exp_f32 v36, v36
  v_cvt_pk_bf16_f32 v33, v34, v35
  v_exp_f32 v37, v37
  v_exp_f32 v38, v38
  v_mfma_f32_32x32x16_bf16 v[16:31], v[80:83], v[8:11], 0
  s_add_u32 s21, s21, 1
  v_cvt_pk_bf16_f32 v34, v36, v37
  v_exp_f32 v39, v39
  v_exp_f32 v40, v40
  v_cvt_pk_bf16_f32 v35, v38, v39
  v_exp_f32 v41, v41
  v_exp_f32 v42, v42
  v_mfma_f32_32x32x16_bf16 v[64:79], v[96:99], v[32:35], v[64:79]
  s_cmp_lt_u32 s21, 8
  v_cvt_pk_bf16_f32 v36, v40, v41
  v_exp_f32 v43, v43
  v_exp_f32 v44, v44
  v_cvt_pk_bf16_f32 v37, v42, v43
  v_exp_f32 v45, v45
  v_exp_f32 v46, v46
  v_cvt_pk_bf16_f32 v38, v44, v45
  v_exp_f32 v47, v47
  v_add_u32 v104, 8192, v104
  v_add_u32 v105, v106, v105
  s_cbranch_scc1 att_f_loop
  s_branch att_f_drain
att_f_bar:
  s_lshl_b32 s28, s21, 1
  s_and_b32 s28, s28, 4
  s_add_u32 s28, s28, 143360
  v_mov_b32 v5, s28
  s_mov_b32 s29, 0
att_f_kvp:
  ds_read_b32 v6, v5
  s_waitcnt lgkmcnt(0)
  v_readfirstlane_b32 s30, v6
  s_add_u32 s29, s29, 1
  s_cmp_gt_u32 s29, 1600000
  s_cbranch_scc1 att_f_nobar
  s_cmp_lt_u32 s30, 4
  s_cbranch_scc1 att_f_kvp
  s_branch att_f_nobar
att_f_drain:
  v_cvt_pk_bf16_f32 v39, v46, v47
  s_nop 1
  v_mfma_f32_32x32x16_bf16 v[64:79], v[100:103], v[36:39], v[64:79]
  s_branch att_epi
att_slow:
  s_waitcnt vmcnt(0)
  v_mov_b32 v5, 143368
  v_mov_b32 v6, 1
  s_mov_b64 exec, 1
  ds_add_u32 v5, v6
  s_mov_b64 exec, -1
  v_mov_b32 v5, 143360
  s_mov_b32 s29, 0
att_kvs:
  ds_read_b64 v[6:7], v5
  s_waitcnt lgkmcnt(0)
  v_add_u32 v6, v6, v7
  s_add_u32 s29, s29, 1
  v_readfirstlane_b32 s30, v6
  s_cmp_gt_u32 s29, 1600000
  s_cbranch_scc1 att_kvsd
  s_cmp_lt_u32 s30, 8
  s_cbranch_scc1 att_kvs
att_kvsd:
  v_mov_b32 v2, 0xff800000
  v_mov_b32 v3, 0xff800000
  v_mov_b32 v4, v104
  s_mov_b32 s21, 0
att_mx:
  ds_read_b128 v[84:87], v4
  v_add_u32 v4, 1024, v4
  s_waitcnt lgkmcnt(0)
  v_mfma_f32_32x32x16_bf16 v[16:31], v[84:87], v[8:11], 0
  v_mfma_f32_32x32x16_bf16 v[112:127], v[84:87], v[12:15], 0
  s_nop 15
  v_max3_f32 v2, v2, v16, v17
  v_max3_f32 v2, v2, v18, v19
  v_max3_f32 v2, v2, v20, v21
  v_max3_f32 v2, v2, v22, v23
  v_max3_f32 v2, v2, v24, v25
  v_max3_f32 v2, v2, v26, v27
  v_max3_f32 v2, v2, v28, v29
  v_max3_f32 v2, v2, v30, v31
  v_max3_f32 v3, v3, v112, v113
  v_max3_f32 v3, v3, v114, v115
  v_max3_f32 v3, v3, v116, v117
  v_max3_f32 v3, v3, v118, v119
  v_max3_f32 v3, v3, v120, v121
  v_max3_f32 v3, v3, v122, v123
  v_max3_f32 v3, v3, v124, v125
  v_max3_f32 v3, v3, v126, v127
  s_add_u32 s21, s21, 1
  s_cmp_lt_u32 s21, 64
  s_cbranch_scc1 att_mx
  v_mov_b32 v5, v2
  s_nop 1
  v_permlane32_swap_b32 v2, v5
  s_nop 1
  v_max_f32 v2, v2, v5
  v_mov_b32 v5, v3
  s_nop 1
  v_permlane32_swap_b32 v3, v5
  s_nop 1
  v_max_f32 v3, v3, v5
  v_sub_f32 v112, 0, v2
  v_sub_f32 v128, 0, v3
  v_sub_f32 v113, 0, v2
  v_sub_f32 v129, 0, v3
  v_sub_f32 v114, 0, v2
  v_sub_f32 v130, 0, v3
  v_sub_f32 v115, 0, v2
  v_sub_f32 v131, 0, v3
  v_sub_f32 v116, 0, v2
  v_sub_f32 v132, 0, v3
  v_sub_f32 v117, 0, v2
  v_sub_f32 v133, 0, v3
  v_sub_f32 v118, 0, v2
  v_sub_f32 v134, 0, v3
  v_sub_f32 v119, 0, v2
  v_sub_f32 v135, 0, v3
  v_sub_f32 v120, 0, v2
  v_sub_f32 v136, 0, v3
  v_sub_f32 v121, 0, v2
  v_sub_f32 v137, 0, v3
  v_sub_f32 v122, 0, v2
  v_sub_f32 v138, 0, v3
  v_sub_f32 v123, 0, v2
  v_sub_f32 v139, 0, v3
  v_sub_f32 v124, 0, v2
  v_sub_f32 v140, 0, v3
  v_sub_f32 v125, 0, v2
  v_sub_f32 v141, 0, v3
  v_sub_f32 v126, 0, v2
  v_sub_f32 v142, 0, v3
  v_sub_f32 v127, 0, v2
  v_sub_f32 v143, 0, v3
  s_nop 1
  v_mfma_f32_32x32x16_bf16 v[16:31], v[80:83], v[8:11], v[112:127]
  s_nop 7
  s_nop 3
  s_mov_b32 s21, 0
  .p2align 6
att_s_loop:
att_s_nobar:
  v_exp_f32 v16, v16
  v_cvt_pk_bf16_f32 v39, v46, v47
  v_exp_f32 v17, v17
  v_exp_f32 v18, v18
  v_mfma_f32_32x32x16_bf16 v[64:79], v[100:103], v[36:39], v[64:79]
  ds_read_b128 v[84:87], v104 offset:1024
  v_cvt_pk_bf16_f32 v16, v16, v17
  v_exp_f32 v19, v19
  v_exp_f32 v20, v20
  v_cvt_pk_bf16_f32 v17, v18, v19
  v_exp_f32 v21, v21
  v_exp_f32 v22, v22
  v_mfma_f32_32x32x16_bf16 v[32:47], v[80:83], v[12:15], v[128:143]
  ds_read_b128 v[96:99], v105 offset:1024
  v_cvt_pk_bf16_f32 v18, v20, v21
  v_exp_f32 v23, v23
  v_exp_f32 v24, v24
  v_cvt_pk_bf16_f32 v19, v22, v23
  v_exp_f32 v25, v25
  v_exp_f32 v26, v26
  v_mfma_f32_32x32x16_bf16 v[48:63], v[88:91], v[16:19], v[48:63]
  ds_read_b128 v[100:103], v105 offset:1536
  v_cvt_pk_bf16_f32 v20, v24, v25
  v_exp_f32 v27, v27
  v_exp_f32 v28, v28
  v_cvt_pk_bf16_f32 v21, v26, v27
  v_exp_f32 v29, v29
  v_exp_f32 v30, v30
  v_cvt_pk_bf16_f32 v22, v28, v29
  v_exp_f32 v31, v31
  v_exp_f32 v32, v32
  v_cvt_pk_bf16_f32 v23, v30, v31
  v_exp_f32 v33, v33
  v_exp_f32 v34, v34
  v_mfma_f32_32x32x16_bf16 v[48:63], v[92:95], v[20:23], v[48:63]
  s_waitcnt lgkmcnt(0)
  v_cvt_pk_bf16_f32 v32, v32, v33
  v_exp_f32 v35, v35
  v_exp_f32 v36, v36
  v_cvt_pk_bf16_f32 v33, v34, v35
  v_exp_f32 v37, v37
  v_exp_f32 v38, v38
  v_mfma_f32_32x32x16_bf16 v[16:31], v[84:87], v[8:11], v[112:127]
  v_cvt_pk_bf16_f32 v34, v36, v37
  v_exp_f32 v39, v39
  v_exp_f32 v40, v40
  v_cvt_pk_bf16_f32 v35, v38, v39
  v_exp_f32 v41, v41
  v_exp_f32 v42, v42
  v_mfma_f32_32x32x16_bf16 v[64:79], v[88:91], v[32:35], v[64:79]
  v_cvt_pk_bf16_f32 v36, v40, v41
  v_exp_f32 v43, v43
  v_exp_f32 v44, v44
  v_cvt_pk_bf16_f32 v37, v42, v43
  v_exp_f32 v45, v45
  v_exp_f32 v46, v46
  v_cvt_pk_bf16_f32 v38, v44, v45
  v_exp_f32 v47, v47
  v_exp_f32 v16, v16
  v_cvt_pk_bf16_f32 v39, v46, v47
  v_exp_f32 v17, v17
  v_exp_f32 v18, v18
  v_mfma_f32_32x32x16_bf16 v[64:79], v[92:95], v[36:39], v[64:79]
  ds_read_b128 v[80:83], v104 offset:2048
  v_cvt_pk_bf16_f32 v16, v16, v17
  v_exp_f32 v19, v19
  v_exp_f32 v20, v20
  v_cvt_pk_bf16_f32 v17, v18, v19
  v_exp_f32 v21, v21
  v_exp_f32 v22, v22
  v_mfma_f32_32x32x16_bf16 v[32:47], v[84:87], v[12:15], v[128:143]
  ds_read_b128 v[88:91], v105 offset:2048
  v_cvt_pk_bf16_f32 v18, v20, v21
  v_exp_f32 v23, v23
  v_exp_f32 v24, v24
  v_cvt_pk_bf16_f32 v19, v22, v23
  v_exp_f32 v25, v25
  v_exp_f32 v26, v26
  v_mfma_f32_32x32x16_bf16 v[48:63], v[96:99], v[16:19], v[48:63]
  ds_read_b128 v[92:95], v105 offset:2560
  v_cvt_pk_bf16_f32 v20, v24, v25
  v_exp_f32 v27, v27
  v_exp_f32 v28, v28
  v_cvt_pk_bf16_f32 v21, v26, v27
  v_exp_f32 v29, v29
  v_exp_f32 v30, v30
  v_cvt_pk_bf16_f32 v22, v28, v29
  v_exp_f32 v31, v31
  v_exp_f32 v32, v32
  v_cvt_pk_bf16_f32 v23, v30, v31
  v_exp_f32 v33, v33
  v_exp_f32 v34, v34
  v_mfma_f32_32x32x16_bf16 v[48:63], v[100:103], v[20:23], v[48:63]
  s_waitcnt lgkmcnt(0)
  v_cvt_pk_bf16_f32 v32, v32, v33
  v_exp_f32 v35, v35
  v_exp_f32 v36, v36
  v_cvt_pk_bf16_f32 v33, v34, v35
  v_exp_f32 v37, v37
  v_exp_f32 v38, v38
  v_mfma_f32_32x32x16_bf16 v[16:31], v[80:83], v[8:11], v[112:127]
  v_cvt_pk_bf16_f32 v34, v36, v37
  v_exp_f32 v39, v39
  v_exp_f32 v40, v40
  v_cvt_pk_bf16_f32 v35, v38, v39
  v_exp_f32 v41, v41
  v_exp_f32 v42, v42
  v_mfma_f32_32x32x16_bf16 v[64:79], v[96:99], v[32:35], v[64:79]
  v_cvt_pk_bf16_f32 v36, v40, v41
  v_exp_f32 v43, v43
  v_exp_f32 v44, v44
  v_cvt_pk_bf16_f32 v37, v42, v43
  v_exp_f32 v45, v45
  v_exp_f32 v46, v46
  v_cvt_pk_bf16_f32 v38, v44, v45
  v_exp_f32 v47, v47
  v_exp_f32 v16, v16
  v_cvt_pk_bf16_f32 v39, v46, v47
  v_exp_f32 v17, v17
  v_exp_f32 v18, v18
  v_mfma_f32_32x32x16_bf16 v[64:79], v[100:103], v[36:39], v[64:79]
  ds_read_b128 v[84:87], v104 offset:3072
  v_cvt_pk_bf16_f32 v16, v16, v17
  v_exp_f32 v19, v19
  v_exp_f32 v20, v20
  v_cvt_pk_bf16_f32 v17, v18, v19
  v_exp_f32 v21, v21
  v_exp_f32 v22, v22
  v_mfma_f32_32x32x16_bf16 v[32:47], v[80:83], v[12:15], v[128:143]
  ds_read_b128 v[96:99], v105 offset:3072
  v_cvt_pk_bf16_f32 v18, v20, v21
  v_exp_f32 v23, v23
  v_exp_f32 v24, v24
  v_cvt_pk_bf16_f32 v19, v22, v23
  v_exp_f32 v25, v25
  v_exp_f32 v26, v26
  v_mfma_f32_32x32x16_bf16 v[48:63], v[88:91], v[16:19], v[48:63]
  ds_read_b128 v[100:103], v105 offset:3584
  v_cvt_pk_bf16_f32 v20, v24, v25
  v_exp_f32 v27, v27
  v_exp_f32 v28, v28
  v_cvt_pk_bf16_f32 v21, v26, v27
  v_exp_f32 v29, v29
  v_exp_f32 v30, v30
  v_cvt_pk_bf16_f32 v22, v28, v29
  v_exp_f32 v31, v31
  v_exp_f32 v32, v32
  v_cvt_pk_bf16_f32 v23, v30, v31
  v_exp_f32 v33, v33
  v_exp_f32 v34, v34
  v_mfma_f32_32x32x16_bf16 v[48:63], v[92:95], v[20:23], v[48:63]
  s_waitcnt lgkmcnt(0)
  v_cvt_pk_bf16_f32 v32, v32, v33
  v_exp_f32 v35, v35
  v_exp_f32 v36, v36
  v_cvt_pk_bf16_f32 v33, v34, v35
  v_exp_f32 v37, v37
  v_exp_f32 v38, v38
  v_mfma_f32_32x32x16_bf16 v[16:31], v[84:87], v[8:11], v[112:127]
  v_cvt_pk_bf16_f32 v34, v36, v37
  v_exp_f32 v39, v39
  v_exp_f32 v40, v40
  v_cvt_pk_bf16_f32 v35, v38, v39
  v_exp_f32 v41, v41
  v_exp_f32 v42, v42
  v_mfma_f32_32x32x16_bf16 v[64:79], v[88:91], v[32:35], v[64:79]
  v_cvt_pk_bf16_f32 v36, v40, v41
  v_exp_f32 v43, v43
  v_exp_f32 v44, v44
  v_cvt_pk_bf16_f32 v37, v42, v43
  v_exp_f32 v45, v45
  v_exp_f32 v46, v46
  v_cvt_pk_bf16_f32 v38, v44, v45
  v_exp_f32 v47, v47
  v_exp_f32 v16, v16
  v_cvt_pk_bf16_f32 v39, v46, v47
  v_exp_f32 v17, v17
  v_exp_f32 v18, v18
  v_mfma_f32_32x32x16_bf16 v[64:79], v[92:95], v[36:39], v[64:79]
  ds_read_b128 v[80:83], v104 offset:4096
  v_cvt_pk_bf16_f32 v16, v16, v17
  v_exp_f32 v19, v19
  v_exp_f32 v20, v20
  v_cvt_pk_bf16_f32 v17, v18, v19
  v_exp_f32 v21, v21
  v_exp_f32 v22, v22
  v_mfma_f32_32x32x16_bf16 v[32:47], v[84:87], v[12:15], v[128:143]
  ds_read_b128 v[88:91], v105 offset:4096
  v_cvt_pk_bf16_f32 v18, v20, v21
  v_exp_f32 v23, v23
  v_exp_f32 v24, v24
  v_cvt_pk_bf16_f32 v19, v22, v23
  v_exp_f32 v25, v25
  v_exp_f32 v26, v26
  v_mfma_f32_32x32x16_bf16 v[48:63], v[96:99], v[16:19], v[48:63]
  ds_read_b128 v[92:95], v105 offset:4608
  v_cvt_pk_bf16_f32 v20, v24, v25
  v_exp_f32 v27, v27
  v_exp_f32 v28, v28
  v_cvt_pk_bf16_f32 v21, v26, v27
  v_exp_f32 v29, v29
  v_exp_f32 v30, v30
  v_cvt_pk_bf16_f32 v22, v28, v29
  v_exp_f32 v31, v31
  v_exp_f32 v32, v32
  v_cvt_pk_bf16_f32 v23, v30, v31
  v_exp_f32 v33, v33
  v_exp_f32 v34, v34
  v_mfma_f32_32x32x16_bf16 v[48:63], v[100:103], v[20:23], v[48:63]
  s_waitcnt lgkmcnt(0)
  v_cvt_pk_bf16_f32 v32, v32, v33
  v_exp_f32 v35, v35
  v_exp_f32 v36, v36
  v_cvt_pk_bf16_f32 v33, v34, v35
  v_exp_f32 v37, v37
  v_exp_f32 v38, v38
  v_mfma_f32_32x32x16_bf16 v[16:31], v[80:83], v[8:11], v[112:127]
  v_cvt_pk_bf16_f32 v34, v36, v37
  v_exp_f32 v39, v39
  v_exp_f32 v40, v40
  v_cvt_pk_bf16_f32 v35, v38, v39
  v_exp_f32 v41, v41
  v_exp_f32 v42, v42
  v_mfma_f32_32x32x16_bf16 v[64:79], v[96:99], v[32:35], v[64:79]
  v_cvt_pk_bf16_f32 v36, v40, v41
  v_exp_f32 v43, v43
  v_exp_f32 v44, v44
  v_cvt_pk_bf16_f32 v37, v42, v43
  v_exp_f32 v45, v45
  v_exp_f32 v46, v46
  v_cvt_pk_bf16_f32 v38, v44, v45
  v_exp_f32 v47, v47
  v_exp_f32 v16, v16
  v_cvt_pk_bf16_f32 v39, v46, v47
  v_exp_f32 v17, v17
  v_exp_f32 v18, v18
  v_mfma_f32_32x32x16_bf16 v[64:79], v[100:103], v[36:39], v[64:79]
  ds_read_b128 v[84:87], v104 offset:5120
  v_cvt_pk_bf16_f32 v16, v16, v17
  v_exp_f32 v19, v19
  v_exp_f32 v20, v20
  v_cvt_pk_bf16_f32 v17, v18, v19
  v_exp_f32 v21, v21
  v_exp_f32 v22, v22
  v_mfma_f32_32x32x16_bf16 v[32:47], v[80:83], v[12:15], v[128:143]
  ds_read_b128 v[96:99], v105 offset:5120
  v_cvt_pk_bf16_f32 v18, v20, v21
  v_exp_f32 v23, v23
  v_exp_f32 v24, v24
  v_cvt_pk_bf16_f32 v19, v22, v23
  v_exp_f32 v25, v25
  v_exp_f32 v26, v26
  v_mfma_f32_32x32x16_bf16 v[48:63], v[88:91], v[16:19], v[48:63]
  ds_read_b128 v[100:103], v105 offset:5632
  v_cvt_pk_bf16_f32 v20, v24, v25
  v_exp_f32 v27, v27
  v_exp_f32 v28, v28
  v_cvt_pk_bf16_f32 v21, v26, v27
  v_exp_f32 v29, v29
  v_exp_f32 v30, v30
  v_cvt_pk_bf16_f32 v22, v28, v29
  v_exp_f32 v31, v31
  v_exp_f32 v32, v32
  v_cvt_pk_bf16_f32 v23, v30, v31
  v_exp_f32 v33, v33
  v_exp_f32 v34, v34
  v_mfma_f32_32x32x16_bf16 v[48:63], v[92:95], v[20:23], v[48:63]
  s_waitcnt lgkmcnt(0)
  v_cvt_pk_bf16_f32 v32, v32, v33
  v_exp_f32 v35, v35
  v_exp_f32 v36, v36
  v_cvt_pk_bf16_f32 v33, v34, v35
  v_exp_f32 v37, v37
  v_exp_f32 v38, v38
  v_mfma_f32_32x32x16_bf16 v[16:31], v[84:87], v[8:11], v[112:127]
  v_cvt_pk_bf16_f32 v34, v36, v37
  v_exp_f32 v39, v39
  v_exp_f32 v40, v40
  v_cvt_pk_bf16_f32 v35, v38, v39
  v_exp_f32 v41, v41
  v_exp_f32 v42, v42
  v_mfma_f32_32x32x16_bf16 v[64:79], v[88:91], v[32:35], v[64:79]
  v_cvt_pk_bf16_f32 v36, v40, v41
  v_exp_f32 v43, v43
  v_exp_f32 v44, v44
  v_cvt_pk_bf16_f32 v37, v42, v43
  v_exp_f32 v45, v45
  v_exp_f32 v46, v46
  v_cvt_pk_bf16_f32 v38, v44, v45
  v_exp_f32 v47, v47
  v_exp_f32 v16, v16
  v_cvt_pk_bf16_f32 v39, v46, v47
  v_exp_f32 v17, v17
  v_exp_f32 v18, v18
  v_mfma_f32_32x32x16_bf16 v[64:79], v[92:95], v[36:39], v[64:79]
  ds_read_b128 v[80:83], v104 offset:6144
  v_cvt_pk_bf16_f32 v16, v16, v17
  v_exp_f32 v19, v19
  v_exp_f32 v20, v20
  v_cvt_pk_bf16_f32 v17, v18, v19
  v_exp_f32 v21, v21
  v_exp_f32 v22, v22
  v_mfma_f32_32x32x16_bf16 v[32:47], v[84:87], v[12:15], v[128:143]
  ds_read_b128 v[88:91], v105 offset:6144
  v_cvt_pk_bf16_f32 v18, v20, v21
  v_exp_f32 v23, v23
  v_exp_f32 v24, v24
  v_cvt_pk_bf16_f32 v19, v22, v23
  v_exp_f32 v25, v25
  v_exp_f32 v26, v26
  v_mfma_f32_32x32x16_bf16 v[48:63], v[96:99], v[16:19], v[48:63]
  ds_read_b128 v[92:95], v105 offset:6656
  v_cvt_pk_bf16_f32 v20, v24, v25
  v_exp_f32 v27, v27
  v_exp_f32 v28, v28
  v_cvt_pk_bf16_f32 v21, v26, v27
  v_exp_f32 v29, v29
  v_exp_f32 v30, v30
  v_cvt_pk_bf16_f32 v22, v28, v29
  v_exp_f32 v31, v31
  v_exp_f32 v32, v32
  v_cvt_pk_bf16_f32 v23, v30, v31
  v_exp_f32 v33, v33
  v_exp_f32 v34, v34
  v_mfma_f32_32x32x16_bf16 v[48:63], v[100:103], v[20:23], v[48:63]
  s_waitcnt lgkmcnt(0)
  v_cvt_pk_bf16_f32 v32, v32, v33
  v_exp_f32 v35, v35
  v_exp_f32 v36, v36
  v_cvt_pk_bf16_f32 v33, v34, v35
  v_exp_f32 v37, v37
  v_exp_f32 v38, v38
  v_mfma_f32_32x32x16_bf16 v[16:31], v[80:83], v[8:11], v[112:127]
  v_cvt_pk_bf16_f32 v34, v36, v37
  v_exp_f32 v39, v39
  v_exp_f32 v40, v40
  v_cvt_pk_bf16_f32 v35, v38, v39
  v_exp_f32 v41, v41
  v_exp_f32 v42, v42
  v_mfma_f32_32x32x16_bf16 v[64:79], v[96:99], v[32:35], v[64:79]
  v_cvt_pk_bf16_f32 v36, v40, v41
  v_exp_f32 v43, v43
  v_exp_f32 v44, v44
  v_cvt_pk_bf16_f32 v37, v42, v43
  v_exp_f32 v45, v45
  v_exp_f32 v46, v46
  v_cvt_pk_bf16_f32 v38, v44, v45
  v_exp_f32 v47, v47
  v_exp_f32 v16, v16
  v_cvt_pk_bf16_f32 v39, v46, v47
  v_exp_f32 v17, v17
  v_exp_f32 v18, v18
  v_mfma_f32_32x32x16_bf16 v[64:79], v[100:103], v[36:39], v[64:79]
  ds_read_b128 v[84:87], v104 offset:7168
  v_cvt_pk_bf16_f32 v16, v16, v17
  v_exp_f32 v19, v19
  v_exp_f32 v20, v20
  v_cvt_pk_bf16_f32 v17, v18, v19
  v_exp_f32 v21, v21
  v_exp_f32 v22, v22
  v_mfma_f32_32x32x16_bf16 v[32:47], v[80:83], v[12:15], v[128:143]
  ds_read_b128 v[96:99], v105 offset:7168
  v_cvt_pk_bf16_f32 v18, v20, v21
  v_exp_f32 v23, v23
  v_exp_f32 v24, v24
  v_cvt_pk_bf16_f32 v19, v22, v23
  v_exp_f32 v25, v25
  v_exp_f32 v26, v26
  v_mfma_f32_32x32x16_bf16 v[48:63], v[88:91], v[16:19], v[48:63]
  ds_read_b128 v[100:103], v105 offset:7680
  v_cvt_pk_bf16_f32 v20, v24, v25
  v_exp_f32 v27, v27
  v_exp_f32 v28, v28
  v_cvt_pk_bf16_f32 v21, v26, v27
  v_exp_f32 v29, v29
  v_exp_f32 v30, v30
  v_cvt_pk_bf16_f32 v22, v28, v29
  v_exp_f32 v31, v31
  v_exp_f32 v32, v32
  v_cvt_pk_bf16_f32 v23, v30, v31
  v_exp_f32 v33, v33
  v_exp_f32 v34, v34
  v_mfma_f32_32x32x16_bf16 v[48:63], v[92:95], v[20:23], v[48:63]
  s_waitcnt lgkmcnt(0)
  v_cvt_pk_bf16_f32 v32, v32, v33
  v_exp_f32 v35, v35
  v_exp_f32 v36, v36
  v_cvt_pk_bf16_f32 v33, v34, v35
  v_exp_f32 v37, v37
  v_exp_f32 v38, v38
  v_mfma_f32_32x32x16_bf16 v[16:31], v[84:87], v[8:11], v[112:127]
  v_cvt_pk_bf16_f32 v34, v36, v37
  v_exp_f32 v39, v39
  v_exp_f32 v40, v40
  v_cvt_pk_bf16_f32 v35, v38, v39
  v_exp_f32 v41, v41
  v_exp_f32 v42, v42
  v_mfma_f32_32x32x16_bf16 v[64:79], v[88:91], v[32:35], v[64:79]
  v_cvt_pk_bf16_f32 v36, v40, v41
  v_exp_f32 v43, v43
  v_exp_f32 v44, v44
  v_cvt_pk_bf16_f32 v37, v42, v43
  v_exp_f32 v45, v45
  v_exp_f32 v46, v46
  v_cvt_pk_bf16_f32 v38, v44, v45
  v_exp_f32 v47, v47
  v_exp_f32 v16, v16
  v_cvt_pk_bf16_f32 v39, v46, v47
  v_exp_f32 v17, v17
  v_exp_f32 v18, v18
  v_mfma_f32_32x32x16_bf16 v[64:79], v[92:95], v[36:39], v[64:79]
  ds_read_b128 v[80:83], v104 offset:8192
  v_cvt_pk_bf16_f32 v16, v16, v17
  v_exp_f32 v19, v19
  v_exp_f32 v20, v20
  v_cvt_pk_bf16_f32 v17, v18, v19
  v_exp_f32 v21, v21
  v_exp_f32 v22, v22
  v_mfma_f32_32x32x16_bf16 v[32:47], v[84:87], v[12:15], v[128:143]
  ds_read_b128 v[88:91], v105 offset:8192
  v_cvt_pk_bf16_f32 v18, v20, v21
  v_exp_f32 v23, v23
  v_exp_f32 v24, v24
  v_cvt_pk_bf16_f32 v19, v22, v23
  v_exp_f32 v25, v25
  v_exp_f32 v26, v26
  v_mfma_f32_32x32x16_bf16 v[48:63], v[96:99], v[16:19], v[48:63]
  ds_read_b128 v[92:95], v105 offset:8704
  v_cvt_pk_bf16_f32 v20, v24, v25
  v_exp_f32 v27, v27
  v_exp_f32 v28, v28
  v_cvt_pk_bf16_f32 v21, v26, v27
  v_exp_f32 v29, v29
  v_exp_f32 v30, v30
  v_cvt_pk_bf16_f32 v22, v28, v29
  v_exp_f32 v31, v31
  v_exp_f32 v32, v32
  v_cvt_pk_bf16_f32 v23, v30, v31
  v_exp_f32 v33, v33
  v_exp_f32 v34, v34
  v_mfma_f32_32x32x16_bf16 v[48:63], v[100:103], v[20:23], v[48:63]
  s_waitcnt lgkmcnt(0)
  v_cvt_pk_bf16_f32 v32, v32, v33
  v_exp_f32 v35, v35
  v_exp_f32 v36, v36
  v_cvt_pk_bf16_f32 v33, v34, v35
  v_exp_f32 v37, v37
  v_exp_f32 v38, v38
  v_mfma_f32_32x32x16_bf16 v[16:31], v[80:83], v[8:11], v[112:127]
  s_add_u32 s21, s21, 1
  v_cvt_pk_bf16_f32 v34, v36, v37
  v_exp_f32 v39, v39
  v_exp_f32 v40, v40
  v_cvt_pk_bf16_f32 v35, v38, v39
  v_exp_f32 v41, v41
  v_exp_f32 v42, v42
  v_mfma_f32_32x32x16_bf16 v[64:79], v[96:99], v[32:35], v[64:79]
  s_cmp_lt_u32 s21, 8
  v_cvt_pk_bf16_f32 v36, v40, v41
  v_exp_f32 v43, v43
  v_exp_f32 v44, v44
  v_cvt_pk_bf16_f32 v37, v42, v43
  v_exp_f32 v45, v45
  v_exp_f32 v46, v46
  v_cvt_pk_bf16_f32 v38, v44, v45
  v_exp_f32 v47, v47
  v_add_u32 v104, 8192, v104
  v_add_u32 v105, v106, v105
  s_cbranch_scc1 att_s_loop
  v_cvt_pk_bf16_f32 v39, v46, v47
  s_nop 1
  v_mfma_f32_32x32x16_bf16 v[64:79], v[100:103], v[36:39], v[64:79]
att_epi:
  s_mul_i32 s27, s26, 144
  s_add_u32 s27, s27, s12
  s_add_u32 s27, s27, 112
  s_lshl_b32 s27, s27, 10
  s_add_u32 s27, s27, 10485760
  s_add_u32 s28, s27, 147456
  s_nop 7
  v_mov_b32 v5, v56
  s_nop 1
  v_permlane32_swap_b32 v56, v5
  s_nop 1
  v_rcp_f32 v56, v56
  s_nop 0
  v_mul_f32 v48, v48, v56
  v_mul_f32 v49, v49, v56
  v_mul_f32 v50, v50, v56
  v_mul_f32 v51, v51, v56
  v_mul_f32 v52, v52, v56
  v_mul_f32 v53, v53, v56
  v_mul_f32 v54, v54, v56
  v_mul_f32 v55, v55, v56
  v_cvt_pk_bf16_f32 v48, v48, v49
  v_cvt_pk_bf16_f32 v49, v50, v51
  v_cvt_pk_bf16_f32 v50, v52, v53
  v_cvt_pk_bf16_f32 v51, v54, v55
  buffer_store_dwordx4 v[48:51], v107, s[8:11], s27 offen sc1
  v_mov_b32 v5, v72
  s_nop 1
  v_permlane32_swap_b32 v72, v5
  s_nop 1
  v_rcp_f32 v72, v72
  s_nop 0
  v_mul_f32 v64, v64, v72
  v_mul_f32 v65, v65, v72
  v_mul_f32 v66, v66, v72
  v_mul_f32 v67, v67, v72
  v_mul_f32 v68, v68, v72
  v_mul_f32 v69, v69, v72
  v_mul_f32 v70, v70, v72
  v_mul_f32 v71, v71, v72
  v_cvt_pk_bf16_f32 v64, v64, v65
  v_cvt_pk_bf16_f32 v65, v66, v67
  v_cvt_pk_bf16_f32 v66, v68, v69
  v_cvt_pk_bf16_f32 v67, v70, v71
  buffer_store_dwordx4 v[64:67], v107, s[8:11], s28 offen sc1
  s_lshl_b32 s29, s13, 2
  s_add_u32 s29, s29, s14
  s_lshl_b32 s29, s29, 5
  s_add_u32 s29, s29, s12
  s_lshl_b32 s29, s29, 2
  s_add_u32 s29, s29, 20971520
  v_mov_b32 v6, 0
  v_mov_b32 v5, s36
  s_waitcnt vmcnt(0)
  s_mov_b64 exec, 1
  buffer_store_dword v5, v6, s[8:11], s29 offen sc1
  s_mov_b64 exec, -1
  v_lshrrev_b32 v241, 3, v244
  v_and_b32 v242, 7, v244
  v_lshlrev_b32 v245, 10, v241
  v_lshl_add_u32 v245, v242, 4, v245
  v_mul_u32_u24 v246, 272, v241
  v_lshl_add_u32 v246, v242, 5, v246
  s_bfe_u32 s28, s12, 0x20001
  s_lshl_b32 s37, s13, 2
  s_add_u32 s37, s37, s28
  s_and_b32 s28, s12, 1
  s_lshl_b32 s28, s28, 2
  s_lshr_b32 s30, s12, 3
  s_add_u32 s38, s28, s30
  s_lshl_b32 s39, s37, 16
  s_lshl_b32 s30, s38, 7
  s_add_u32 s39, s39, s30
  buffer_load_dwordx4 v[240:243], v245, s[44:47], s39 offen
  s_barrier
  s_barrier
  s_branch att_fin
att_gem:
  s_bfe_u32 s28, s12, 0x20001
  s_lshl_b32 s37, s13, 2
  s_add_u32 s37, s37, s28
  s_and_b32 s28, s12, 1
  s_lshl_b32 s28, s28, 2
  s_lshr_b32 s30, s12, 3
  s_add_u32 s38, s28, s30
  s_mul_i32 s28, s17, 28
  s_mul_i32 s32, s38, 288
  s_add_u32 s32, s32, s28
  s_lshl_b32 s32, s32, 10
  s_add_u32 s32, s32, 7340032
  s_add_u32 s33, s32, 147456
  s_mul_i32 s34, s37, 288
  s_add_u32 s34, s34, s28
  s_lshl_b32 s34, s34, 10
  s_add_u32 s34, s34, 10485760
  s_add_u32 s35, s34, 147456
  s_waitcnt vmcnt(0)
  s_barrier
  s_cmp_eq_u32 s14, 4
  s_cbranch_scc0 att_f2n
  v_mov_b32 v5, s36
  v_mov_b32 v6, 0
  s_and_b32 s28, s2, 7
  s_lshl_b32 s28, s28, 5
  s_lshr_b32 s29, s2, 3
  s_add_u32 s28, s28, s29
  s_lshl_b32 s28, s28, 2
  s_add_u32 s28, s28, 20979712
  s_mov_b64 exec, 1
  buffer_store_dword v5, v6, s[8:11], s91 offen sc1
  buffer_store_dword v5, v6, s[8:11], s28 offen sc1
  s_mov_b64 exec, -1
att_f2n:
  s_lshr_b32 s28, s17, 1
  s_and_b32 s29, s17, 1
  s_mul_i32 s29, s29, 8
  s_add_u32 s29, s29, 16
  s_lshl_b32 s29, s29, 10
  s_lshl_b32 s22, s28, 16
  s_add_u32 s22, s22, s29
  s_lshl_b32 s25, s28, 21
  s_add_u32 s25, s25, s24
  s_add_u32 s25, s25, s29
  s_add_u32 s25, s25, 2097152
  s_mov_b32 m0, s22
  s_nop 0
  buffer_load_dwordx4 v107, s[8:11], s25 offen offset:0 sc1 lds
  buffer_load_dwordx4 v107, s[8:11], s25 offen offset:1024 sc1 lds
  buffer_load_dwordx4 v107, s[8:11], s25 offen offset:2048 sc1 lds
  buffer_load_dwordx4 v107, s[8:11], s25 offen offset:3072 sc1 lds
  s_add_u32 s22, s22, 4096
  s_add_u32 s25, s25, 4096
  s_mov_b32 m0, s22
  s_nop 0
  buffer_load_dwordx4 v107, s[8:11], s25 offen offset:0 sc1 lds
  buffer_load_dwordx4 v107, s[8:11], s25 offen offset:1024 sc1 lds
  buffer_load_dwordx4 v107, s[8:11], s25 offen offset:2048 sc1 lds
  buffer_load_dwordx4 v107, s[8:11], s25 offen offset:3072 sc1 lds
  s_waitcnt vmcnt(0)
  v_mov_b32 v5, 143360
  v_mov_b32 v6, 1
  s_mov_b64 exec, 1
  ds_add_u32 v5, v6
  s_mov_b64 exec, -1
  s_lshr_b32 s28, s17, 1
  s_and_b32 s29, s17, 1
  s_mul_i32 s29, s29, 16
  s_add_u32 s29, s29, 32
  s_lshl_b32 s29, s29, 10
  s_lshl_b32 s22, s28, 16
  s_add_u32 s22, s22, s29
  s_lshl_b32 s25, s28, 21
  s_add_u32 s25, s25, s24
  s_add_u32 s25, s25, s29
  s_add_u32 s25, s25, 2097152
  s_mov_b32 m0, s22
  s_nop 0
  buffer_load_dwordx4 v107, s[8:11], s25 offen offset:0 sc1 lds
  buffer_load_dwordx4 v107, s[8:11], s25 offen offset:1024 sc1 lds
  buffer_load_dwordx4 v107, s[8:11], s25 offen offset:2048 sc1 lds
  buffer_load_dwordx4 v107, s[8:11], s25 offen offset:3072 sc1 lds
  s_add_u32 s22, s22, 4096
  s_add_u32 s25, s25, 4096
  s_mov_b32 m0, s22
  s_nop 0
  buffer_load_dwordx4 v107, s[8:11], s25 offen offset:0 sc1 lds
  buffer_load_dwordx4 v107, s[8:11], s25 offen offset:1024 sc1 lds
  buffer_load_dwordx4 v107, s[8:11], s25 offen offset:2048 sc1 lds
  buffer_load_dwordx4 v107, s[8:11], s25 offen offset:3072 sc1 lds
  s_add_u32 s22, s22, 4096
  s_add_u32 s25, s25, 4096
  s_mov_b32 m0, s22
  s_nop 0
  buffer_load_dwordx4 v107, s[8:11], s25 offen offset:0 sc1 lds
  buffer_load_dwordx4 v107, s[8:11], s25 offen offset:1024 sc1 lds
  buffer_load_dwordx4 v107, s[8:11], s25 offen offset:2048 sc1 lds
  buffer_load_dwordx4 v107, s[8:11], s25 offen offset:3072 sc1 lds
  s_add_u32 s22, s22, 4096
  s_add_u32 s25, s25, 4096
  s_mov_b32 m0, s22
  s_nop 0
  buffer_load_dwordx4 v107, s[8:11], s25 offen offset:0 sc1 lds
  buffer_load_dwordx4 v107, s[8:11], s25 offen offset:1024 sc1 lds
  buffer_load_dwordx4 v107, s[8:11], s25 offen offset:2048 sc1 lds
  buffer_load_dwordx4 v107, s[8:11], s25 offen offset:3072 sc1 lds
  v_mov_b32 v16, 0
  v_mov_b32 v17, 0
  v_mov_b32 v18, 0
  v_mov_b32 v19, 0
  v_mov_b32 v20, 0
  v_mov_b32 v21, 0
  v_mov_b32 v22, 0
  v_mov_b32 v23, 0
  v_mov_b32 v24, 0
  v_mov_b32 v25, 0
  v_mov_b32 v26, 0
  v_mov_b32 v27, 0
  v_mov_b32 v28, 0
  v_mov_b32 v29, 0
  v_mov_b32 v30, 0
  v_mov_b32 v31, 0
  v_mov_b32 v32, 0
  v_mov_b32 v33, 0
  v_mov_b32 v34, 0
  v_mov_b32 v35, 0
  v_mov_b32 v36, 0
  v_mov_b32 v37, 0
  v_mov_b32 v38, 0
  v_mov_b32 v39, 0
  v_mov_b32 v40, 0
  v_mov_b32 v41, 0
  v_mov_b32 v42, 0
  v_mov_b32 v43, 0
  v_mov_b32 v44, 0
  v_mov_b32 v45, 0
  v_mov_b32 v46, 0
  v_mov_b32 v47, 0
  v_mov_b32 v48, 0
  v_mov_b32 v49, 0
  v_mov_b32 v50, 0
  v_mov_b32 v51, 0
  v_mov_b32 v52, 0
  v_mov_b32 v53, 0
  v_mov_b32 v54, 0
  v_mov_b32 v55, 0
  v_mov_b32 v56, 0
  v_mov_b32 v57, 0
  v_mov_b32 v58, 0
  v_mov_b32 v59, 0
  v_mov_b32 v60, 0
  v_mov_b32 v61, 0
  v_mov_b32 v62, 0
  v_mov_b32 v63, 0
  v_mov_b32 v64, 0
  v_mov_b32 v65, 0
  v_mov_b32 v66, 0
  v_mov_b32 v67, 0
  v_mov_b32 v68, 0
  v_mov_b32 v69, 0
  v_mov_b32 v70, 0
  v_mov_b32 v71, 0
  v_mov_b32 v72, 0
  v_mov_b32 v73, 0
  v_mov_b32 v74, 0
  v_mov_b32 v75, 0
  v_mov_b32 v76, 0
  v_mov_b32 v77, 0
  v_mov_b32 v78, 0
  v_mov_b32 v79, 0
  s_waitcnt vmcnt(0)
  v_mov_b32 v5, 143364
  v_mov_b32 v6, 1
  s_mov_b64 exec, 1
  ds_add_u32 v5, v6
  s_mov_b64 exec, -1
  s_lshr_b32 s28, s37, 1
  s_lshl_b32 s28, s28, 7
  s_add_u32 s28, s28, 20983808
  s_lshl_b32 s29, s38, 7
  s_add_u32 s29, s29, 20979648
  v_min_u32 v7, 47, v0
  v_lshlrev_b32 v6, 2, v7
  v_mov_b32 v5, s29
  v_cmp_gt_u32 vcc, 16, v7
  v_mov_b32 v8, s28
  s_nop 0
  v_cndmask_b32 v5, v5, v8, vcc
  v_add_u32 v6, v5, v6
  s_mov_b32 s30, 0
att_g2p:
  buffer_load_dword v5, v6, s[8:11], 0 offen sc1
  s_waitcnt vmcnt(0)
  v_cmp_eq_u32 vcc, s36, v5
  s_add_u32 s30, s30, 1
  s_cmp_gt_u32 s30, 200000
  s_cbranch_scc1 att_g2d
  s_cmp_eq_u64 vcc, exec
  s_cbranch_scc0 att_g2p
att_g2d:
  buffer_load_dwordx4 v[112:115], v107, s[8:11], s32 offen offset:0 sc1
  buffer_load_dwordx4 v[116:119], v107, s[8:11], s33 offen offset:0 sc1
  buffer_load_dwordx4 v[120:123], v107, s[8:11], s34 offen offset:0 sc1
  buffer_load_dwordx4 v[124:127], v107, s[8:11], s35 offen offset:0 sc1
  buffer_load_dwordx4 v[128:131], v107, s[8:11], s32 offen offset:1024 sc1
  buffer_load_dwordx4 v[132:135], v107, s[8:11], s33 offen offset:1024 sc1
  buffer_load_dwordx4 v[136:139], v107, s[8:11], s34 offen offset:1024 sc1
  buffer_load_dwordx4 v[140:143], v107, s[8:11], s35 offen offset:1024 sc1
  buffer_load_dwordx4 v[144:147], v107, s[8:11], s32 offen offset:2048 sc1
  buffer_load_dwordx4 v[148:151], v107, s[8:11], s33 offen offset:2048 sc1
  buffer_load_dwordx4 v[152:155], v107, s[8:11], s34 offen offset:2048 sc1
  buffer_load_dwordx4 v[156:159], v107, s[8:11], s35 offen offset:2048 sc1
  s_waitcnt vmcnt(8)
  v_mfma_f32_32x32x16_bf16 v[16:31], v[112:115], v[120:123], v[16:31]
  v_mfma_f32_32x32x16_bf16 v[32:47], v[112:115], v[124:127], v[32:47]
  v_mfma_f32_32x32x16_bf16 v[48:63], v[116:119], v[120:123], v[48:63]
  v_mfma_f32_32x32x16_bf16 v[64:79], v[116:119], v[124:127], v[64:79]
  buffer_load_dwordx4 v[160:163], v107, s[8:11], s32 offen offset:3072 sc1
  buffer_load_dwordx4 v[164:167], v107, s[8:11], s33 offen offset:3072 sc1
  buffer_load_dwordx4 v[168:171], v107, s[8:11], s34 offen offset:3072 sc1
  buffer_load_dwordx4 v[172:175], v107, s[8:11], s35 offen offset:3072 sc1
  s_waitcnt vmcnt(8)
  v_mfma_f32_32x32x16_bf16 v[16:31], v[128:131], v[136:139], v[16:31]
  v_mfma_f32_32x32x16_bf16 v[32:47], v[128:131], v[140:143], v[32:47]
  v_mfma_f32_32x32x16_bf16 v[48:63], v[132:135], v[136:139], v[48:63]
  v_mfma_f32_32x32x16_bf16 v[64:79], v[132:135], v[140:143], v[64:79]
  s_add_u32 s32, s32, 4096
  s_add_u32 s33, s33, 4096
  s_add_u32 s34, s34, 4096
  s_add_u32 s35, s35, 4096
  buffer_load_dwordx4 v[112:115], v107, s[8:11], s32 offen offset:0 sc1
  buffer_load_dwordx4 v[116:119], v107, s[8:11], s33 offen offset:0 sc1
  buffer_load_dwordx4 v[120:123], v107, s[8:11], s34 offen offset:0 sc1
  buffer_load_dwordx4 v[124:127], v107, s[8:11], s35 offen offset:0 sc1
  s_waitcnt vmcnt(8)
  v_mfma_f32_32x32x16_bf16 v[16:31], v[144:147], v[152:155], v[16:31]
  v_mfma_f32_32x32x16_bf16 v[32:47], v[144:147], v[156:159], v[32:47]
  v_mfma_f32_32x32x16_bf16 v[48:63], v[148:151], v[152:155], v[48:63]
  v_mfma_f32_32x32x16_bf16 v[64:79], v[148:151], v[156:159], v[64:79]
  buffer_load_dwordx4 v[128:131], v107, s[8:11], s32 offen offset:1024 sc1
  buffer_load_dwordx4 v[132:135], v107, s[8:11], s33 offen offset:1024 sc1
  buffer_load_dwordx4 v[136:139], v107, s[8:11], s34 offen offset:1024 sc1
  buffer_load_dwordx4 v[140:143], v107, s[8:11], s35 offen offset:1024 sc1
  s_waitcnt vmcnt(8)
  v_mfma_f32_32x32x16_bf16 v[16:31], v[160:163], v[168:171], v[16:31]
  v_mfma_f32_32x32x16_bf16 v[32:47], v[160:163], v[172:175], v[32:47]
  v_mfma_f32_32x32x16_bf16 v[48:63], v[164:167], v[168:171], v[48:63]
  v_mfma_f32_32x32x16_bf16 v[64:79], v[164:167], v[172:175], v[64:79]
  buffer_load_dwordx4 v[144:147], v107, s[8:11], s32 offen offset:2048 sc1
  buffer_load_dwordx4 v[148:151], v107, s[8:11], s33 offen offset:2048 sc1
  buffer_load_dwordx4 v[152:155], v107, s[8:11], s34 offen offset:2048 sc1
  buffer_load_dwordx4 v[156:159], v107, s[8:11], s35 offen offset:2048 sc1
  s_waitcnt vmcnt(8)
  v_mfma_f32_32x32x16_bf16 v[16:31], v[112:115], v[120:123], v[16:31]
  v_mfma_f32_32x32x16_bf16 v[32:47], v[112:115], v[124:127], v[32:47]
  v_mfma_f32_32x32x16_bf16 v[48:63], v[116:119], v[120:123], v[48:63]
  v_mfma_f32_32x32x16_bf16 v[64:79], v[116:119], v[124:127], v[64:79]
  buffer_load_dwordx4 v[160:163], v107, s[8:11], s32 offen offset:3072 sc1
  buffer_load_dwordx4 v[164:167], v107, s[8:11], s33 offen offset:3072 sc1
  buffer_load_dwordx4 v[168:171], v107, s[8:11], s34 offen offset:3072 sc1
  buffer_load_dwordx4 v[172:175], v107, s[8:11], s35 offen offset:3072 sc1
  s_waitcnt vmcnt(8)
  v_mfma_f32_32x32x16_bf16 v[16:31], v[128:131], v[136:139], v[16:31]
  v_mfma_f32_32x32x16_bf16 v[32:47], v[128:131], v[140:143], v[32:47]
  v_mfma_f32_32x32x16_bf16 v[48:63], v[132:135], v[136:139], v[48:63]
  v_mfma_f32_32x32x16_bf16 v[64:79], v[132:135], v[140:143], v[64:79]
  s_add_u32 s32, s32, 4096
  s_add_u32 s33, s33, 4096
  s_add_u32 s34, s34, 4096
  s_add_u32 s35, s35, 4096
  buffer_load_dwordx4 v[112:115], v107, s[8:11], s32 offen offset:0 sc1
  buffer_load_dwordx4 v[116:119], v107, s[8:11], s33 offen offset:0 sc1
  buffer_load_dwordx4 v[120:123], v107, s[8:11], s34 offen offset:0 sc1
  buffer_load_dwordx4 v[124:127], v107, s[8:11], s35 offen offset:0 sc1
  s_waitcnt vmcnt(8)
  v_mfma_f32_32x32x16_bf16 v[16:31], v[144:147], v[152:155], v[16:31]
  v_mfma_f32_32x32x16_bf16 v[32:47], v[144:147], v[156:159], v[32:47]
  v_mfma_f32_32x32x16_bf16 v[48:63], v[148:151], v[152:155], v[48:63]
  v_mfma_f32_32x32x16_bf16 v[64:79], v[148:151], v[156:159], v[64:79]
  buffer_load_dwordx4 v[128:131], v107, s[8:11], s32 offen offset:1024 sc1
  buffer_load_dwordx4 v[132:135], v107, s[8:11], s33 offen offset:1024 sc1
  buffer_load_dwordx4 v[136:139], v107, s[8:11], s34 offen offset:1024 sc1
  buffer_load_dwordx4 v[140:143], v107, s[8:11], s35 offen offset:1024 sc1
  s_waitcnt vmcnt(8)
  v_mfma_f32_32x32x16_bf16 v[16:31], v[160:163], v[168:171], v[16:31]
  v_mfma_f32_32x32x16_bf16 v[32:47], v[160:163], v[172:175], v[32:47]
  v_mfma_f32_32x32x16_bf16 v[48:63], v[164:167], v[168:171], v[48:63]
  v_mfma_f32_32x32x16_bf16 v[64:79], v[164:167], v[172:175], v[64:79]
  buffer_load_dwordx4 v[144:147], v107, s[8:11], s32 offen offset:2048 sc1
  buffer_load_dwordx4 v[148:151], v107, s[8:11], s33 offen offset:2048 sc1
  buffer_load_dwordx4 v[152:155], v107, s[8:11], s34 offen offset:2048 sc1
  buffer_load_dwordx4 v[156:159], v107, s[8:11], s35 offen offset:2048 sc1
  s_waitcnt vmcnt(8)
  v_mfma_f32_32x32x16_bf16 v[16:31], v[112:115], v[120:123], v[16:31]
  v_mfma_f32_32x32x16_bf16 v[32:47], v[112:115], v[124:127], v[32:47]
  v_mfma_f32_32x32x16_bf16 v[48:63], v[116:119], v[120:123], v[48:63]
  v_mfma_f32_32x32x16_bf16 v[64:79], v[116:119], v[124:127], v[64:79]
  buffer_load_dwordx4 v[160:163], v107, s[8:11], s32 offen offset:3072 sc1
  buffer_load_dwordx4 v[164:167], v107, s[8:11], s33 offen offset:3072 sc1
  buffer_load_dwordx4 v[168:171], v107, s[8:11], s34 offen offset:3072 sc1
  buffer_load_dwordx4 v[172:175], v107, s[8:11], s35 offen offset:3072 sc1
  s_waitcnt vmcnt(8)
  v_mfma_f32_32x32x16_bf16 v[16:31], v[128:131], v[136:139], v[16:31]
  v_mfma_f32_32x32x16_bf16 v[32:47], v[128:131], v[140:143], v[32:47]
  v_mfma_f32_32x32x16_bf16 v[48:63], v[132:135], v[136:139], v[48:63]
  v_mfma_f32_32x32x16_bf16 v[64:79], v[132:135], v[140:143], v[64:79]
  s_add_u32 s32, s32, 4096
  s_add_u32 s33, s33, 4096
  s_add_u32 s34, s34, 4096
  s_add_u32 s35, s35, 4096
  buffer_load_dwordx4 v[112:115], v107, s[8:11], s32 offen offset:0 sc1
  buffer_load_dwordx4 v[116:119], v107, s[8:11], s33 offen offset:0 sc1
  buffer_load_dwordx4 v[120:123], v107, s[8:11], s34 offen offset:0 sc1
  buffer_load_dwordx4 v[124:127], v107, s[8:11], s35 offen offset:0 sc1
  s_waitcnt vmcnt(8)
  v_mfma_f32_32x32x16_bf16 v[16:31], v[144:147], v[152:155], v[16:31]
  v_mfma_f32_32x32x16_bf16 v[32:47], v[144:147], v[156:159], v[32:47]
  v_mfma_f32_32x32x16_bf16 v[48:63], v[148:151], v[152:155], v[48:63]
  v_mfma_f32_32x32x16_bf16 v[64:79], v[148:151], v[156:159], v[64:79]
  buffer_load_dwordx4 v[128:131], v107, s[8:11], s32 offen offset:1024 sc1
  buffer_load_dwordx4 v[132:135], v107, s[8:11], s33 offen offset:1024 sc1
  buffer_load_dwordx4 v[136:139], v107, s[8:11], s34 offen offset:1024 sc1
  buffer_load_dwordx4 v[140:143], v107, s[8:11], s35 offen offset:1024 sc1
  s_waitcnt vmcnt(8)
  v_mfma_f32_32x32x16_bf16 v[16:31], v[160:163], v[168:171], v[16:31]
  v_mfma_f32_32x32x16_bf16 v[32:47], v[160:163], v[172:175], v[32:47]
  v_mfma_f32_32x32x16_bf16 v[48:63], v[164:167], v[168:171], v[48:63]
  v_mfma_f32_32x32x16_bf16 v[64:79], v[164:167], v[172:175], v[64:79]
  buffer_load_dwordx4 v[144:147], v107, s[8:11], s32 offen offset:2048 sc1
  buffer_load_dwordx4 v[148:151], v107, s[8:11], s33 offen offset:2048 sc1
  buffer_load_dwordx4 v[152:155], v107, s[8:11], s34 offen offset:2048 sc1
  buffer_load_dwordx4 v[156:159], v107, s[8:11], s35 offen offset:2048 sc1
  s_waitcnt vmcnt(8)
  v_mfma_f32_32x32x16_bf16 v[16:31], v[112:115], v[120:123], v[16:31]
  v_mfma_f32_32x32x16_bf16 v[32:47], v[112:115], v[124:127], v[32:47]
  v_mfma_f32_32x32x16_bf16 v[48:63], v[116:119], v[120:123], v[48:63]
  v_mfma_f32_32x32x16_bf16 v[64:79], v[116:119], v[124:127], v[64:79]
  buffer_load_dwordx4 v[160:163], v107, s[8:11], s32 offen offset:3072 sc1
  buffer_load_dwordx4 v[164:167], v107, s[8:11], s33 offen offset:3072 sc1
  buffer_load_dwordx4 v[168:171], v107, s[8:11], s34 offen offset:3072 sc1
  buffer_load_dwordx4 v[172:175], v107, s[8:11], s35 offen offset:3072 sc1
  s_waitcnt vmcnt(8)
  v_mfma_f32_32x32x16_bf16 v[16:31], v[128:131], v[136:139], v[16:31]
  v_mfma_f32_32x32x16_bf16 v[32:47], v[128:131], v[140:143], v[32:47]
  v_mfma_f32_32x32x16_bf16 v[48:63], v[132:135], v[136:139], v[48:63]
  v_mfma_f32_32x32x16_bf16 v[64:79], v[132:135], v[140:143], v[64:79]
  s_add_u32 s32, s32, 4096
  s_add_u32 s33, s33, 4096
  s_add_u32 s34, s34, 4096
  s_add_u32 s35, s35, 4096
  buffer_load_dwordx4 v[112:115], v107, s[8:11], s32 offen offset:0 sc1
  buffer_load_dwordx4 v[116:119], v107, s[8:11], s33 offen offset:0 sc1
  buffer_load_dwordx4 v[120:123], v107, s[8:11], s34 offen offset:0 sc1
  buffer_load_dwordx4 v[124:127], v107, s[8:11], s35 offen offset:0 sc1
  s_waitcnt vmcnt(8)
  v_mfma_f32_32x32x16_bf16 v[16:31], v[144:147], v[152:155], v[16:31]
  v_mfma_f32_32x32x16_bf16 v[32:47], v[144:147], v[156:159], v[32:47]
  v_mfma_f32_32x32x16_bf16 v[48:63], v[148:151], v[152:155], v[48:63]
  v_mfma_f32_32x32x16_bf16 v[64:79], v[148:151], v[156:159], v[64:79]
  buffer_load_dwordx4 v[128:131], v107, s[8:11], s32 offen offset:1024 sc1
  buffer_load_dwordx4 v[132:135], v107, s[8:11], s33 offen offset:1024 sc1
  buffer_load_dwordx4 v[136:139], v107, s[8:11], s34 offen offset:1024 sc1
  buffer_load_dwordx4 v[140:143], v107, s[8:11], s35 offen offset:1024 sc1
  s_waitcnt vmcnt(8)
  v_mfma_f32_32x32x16_bf16 v[16:31], v[160:163], v[168:171], v[16:31]
  v_mfma_f32_32x32x16_bf16 v[32:47], v[160:163], v[172:175], v[32:47]
  v_mfma_f32_32x32x16_bf16 v[48:63], v[164:167], v[168:171], v[48:63]
  v_mfma_f32_32x32x16_bf16 v[64:79], v[164:167], v[172:175], v[64:79]
  buffer_load_dwordx4 v[144:147], v107, s[8:11], s32 offen offset:2048 sc1
  buffer_load_dwordx4 v[148:151], v107, s[8:11], s33 offen offset:2048 sc1
  buffer_load_dwordx4 v[152:155], v107, s[8:11], s34 offen offset:2048 sc1
  buffer_load_dwordx4 v[156:159], v107, s[8:11], s35 offen offset:2048 sc1
  s_waitcnt vmcnt(8)
  v_mfma_f32_32x32x16_bf16 v[16:31], v[112:115], v[120:123], v[16:31]
  v_mfma_f32_32x32x16_bf16 v[32:47], v[112:115], v[124:127], v[32:47]
  v_mfma_f32_32x32x16_bf16 v[48:63], v[116:119], v[120:123], v[48:63]
  v_mfma_f32_32x32x16_bf16 v[64:79], v[116:119], v[124:127], v[64:79]
  buffer_load_dwordx4 v[160:163], v107, s[8:11], s32 offen offset:3072 sc1
  buffer_load_dwordx4 v[164:167], v107, s[8:11], s33 offen offset:3072 sc1
  buffer_load_dwordx4 v[168:171], v107, s[8:11], s34 offen offset:3072 sc1
  buffer_load_dwordx4 v[172:175], v107, s[8:11], s35 offen offset:3072 sc1
  s_waitcnt vmcnt(8)
  v_mfma_f32_32x32x16_bf16 v[16:31], v[128:131], v[136:139], v[16:31]
  v_mfma_f32_32x32x16_bf16 v[32:47], v[128:131], v[140:143], v[32:47]
  v_mfma_f32_32x32x16_bf16 v[48:63], v[132:135], v[136:139], v[48:63]
  v_mfma_f32_32x32x16_bf16 v[64:79], v[132:135], v[140:143], v[64:79]
  s_add_u32 s32, s32, 4096
  s_add_u32 s33, s33, 4096
  s_add_u32 s34, s34, 4096
  s_add_u32 s35, s35, 4096
  buffer_load_dwordx4 v[112:115], v107, s[8:11], s32 offen offset:0 sc1
  buffer_load_dwordx4 v[116:119], v107, s[8:11], s33 offen offset:0 sc1
  buffer_load_dwordx4 v[120:123], v107, s[8:11], s34 offen offset:0 sc1
  buffer_load_dwordx4 v[124:127], v107, s[8:11], s35 offen offset:0 sc1
  s_waitcnt vmcnt(8)
  v_mfma_f32_32x32x16_bf16 v[16:31], v[144:147], v[152:155], v[16:31]
  v_mfma_f32_32x32x16_bf16 v[32:47], v[144:147], v[156:159], v[32:47]
  v_mfma_f32_32x32x16_bf16 v[48:63], v[148:151], v[152:155], v[48:63]
  v_mfma_f32_32x32x16_bf16 v[64:79], v[148:151], v[156:159], v[64:79]
  buffer_load_dwordx4 v[128:131], v107, s[8:11], s32 offen offset:1024 sc1
  buffer_load_dwordx4 v[132:135], v107, s[8:11], s33 offen offset:1024 sc1
  buffer_load_dwordx4 v[136:139], v107, s[8:11], s34 offen offset:1024 sc1
  buffer_load_dwordx4 v[140:143], v107, s[8:11], s35 offen offset:1024 sc1
  s_waitcnt vmcnt(8)
  v_mfma_f32_32x32x16_bf16 v[16:31], v[160:163], v[168:171], v[16:31]
  v_mfma_f32_32x32x16_bf16 v[32:47], v[160:163], v[172:175], v[32:47]
  v_mfma_f32_32x32x16_bf16 v[48:63], v[164:167], v[168:171], v[48:63]
  v_mfma_f32_32x32x16_bf16 v[64:79], v[164:167], v[172:175], v[64:79]
  buffer_load_dwordx4 v[144:147], v107, s[8:11], s32 offen offset:2048 sc1
  buffer_load_dwordx4 v[148:151], v107, s[8:11], s33 offen offset:2048 sc1
  buffer_load_dwordx4 v[152:155], v107, s[8:11], s34 offen offset:2048 sc1
  buffer_load_dwordx4 v[156:159], v107, s[8:11], s35 offen offset:2048 sc1
  s_waitcnt vmcnt(8)
  v_mfma_f32_32x32x16_bf16 v[16:31], v[112:115], v[120:123], v[16:31]
  v_mfma_f32_32x32x16_bf16 v[32:47], v[112:115], v[124:127], v[32:47]
  v_mfma_f32_32x32x16_bf16 v[48:63], v[116:119], v[120:123], v[48:63]
  v_mfma_f32_32x32x16_bf16 v[64:79], v[116:119], v[124:127], v[64:79]
  buffer_load_dwordx4 v[160:163], v107, s[8:11], s32 offen offset:3072 sc1
  buffer_load_dwordx4 v[164:167], v107, s[8:11], s33 offen offset:3072 sc1
  buffer_load_dwordx4 v[168:171], v107, s[8:11], s34 offen offset:3072 sc1
  buffer_load_dwordx4 v[172:175], v107, s[8:11], s35 offen offset:3072 sc1
  s_waitcnt vmcnt(8)
  v_mfma_f32_32x32x16_bf16 v[16:31], v[128:131], v[136:139], v[16:31]
  v_mfma_f32_32x32x16_bf16 v[32:47], v[128:131], v[140:143], v[32:47]
  v_mfma_f32_32x32x16_bf16 v[48:63], v[132:135], v[136:139], v[48:63]
  v_mfma_f32_32x32x16_bf16 v[64:79], v[132:135], v[140:143], v[64:79]
  s_add_u32 s32, s32, 4096
  s_add_u32 s33, s33, 4096
  s_add_u32 s34, s34, 4096
  s_add_u32 s35, s35, 4096
  buffer_load_dwordx4 v[112:115], v107, s[8:11], s32 offen offset:0 sc1
  buffer_load_dwordx4 v[116:119], v107, s[8:11], s33 offen offset:0 sc1
  buffer_load_dwordx4 v[120:123], v107, s[8:11], s34 offen offset:0 sc1
  buffer_load_dwordx4 v[124:127], v107, s[8:11], s35 offen offset:0 sc1
  s_waitcnt vmcnt(8)
  v_mfma_f32_32x32x16_bf16 v[16:31], v[144:147], v[152:155], v[16:31]
  v_mfma_f32_32x32x16_bf16 v[32:47], v[144:147], v[156:159], v[32:47]
  v_mfma_f32_32x32x16_bf16 v[48:63], v[148:151], v[152:155], v[48:63]
  v_mfma_f32_32x32x16_bf16 v[64:79], v[148:151], v[156:159], v[64:79]
  buffer_load_dwordx4 v[128:131], v107, s[8:11], s32 offen offset:1024 sc1
  buffer_load_dwordx4 v[132:135], v107, s[8:11], s33 offen offset:1024 sc1
  buffer_load_dwordx4 v[136:139], v107, s[8:11], s34 offen offset:1024 sc1
  buffer_load_dwordx4 v[140:143], v107, s[8:11], s35 offen offset:1024 sc1
  s_waitcnt vmcnt(8)
  v_mfma_f32_32x32x16_bf16 v[16:31], v[160:163], v[168:171], v[16:31]
  v_mfma_f32_32x32x16_bf16 v[32:47], v[160:163], v[172:175], v[32:47]
  v_mfma_f32_32x32x16_bf16 v[48:63], v[164:167], v[168:171], v[48:63]
  v_mfma_f32_32x32x16_bf16 v[64:79], v[164:167], v[172:175], v[64:79]
  buffer_load_dwordx4 v[144:147], v107, s[8:11], s32 offen offset:2048 sc1
  buffer_load_dwordx4 v[148:151], v107, s[8:11], s33 offen offset:2048 sc1
  buffer_load_dwordx4 v[152:155], v107, s[8:11], s34 offen offset:2048 sc1
  buffer_load_dwordx4 v[156:159], v107, s[8:11], s35 offen offset:2048 sc1
  s_waitcnt vmcnt(8)
  v_mfma_f32_32x32x16_bf16 v[16:31], v[112:115], v[120:123], v[16:31]
  v_mfma_f32_32x32x16_bf16 v[32:47], v[112:115], v[124:127], v[32:47]
  v_mfma_f32_32x32x16_bf16 v[48:63], v[116:119], v[120:123], v[48:63]
  v_mfma_f32_32x32x16_bf16 v[64:79], v[116:119], v[124:127], v[64:79]
  buffer_load_dwordx4 v[160:163], v107, s[8:11], s32 offen offset:3072 sc1
  buffer_load_dwordx4 v[164:167], v107, s[8:11], s33 offen offset:3072 sc1
  buffer_load_dwordx4 v[168:171], v107, s[8:11], s34 offen offset:3072 sc1
  buffer_load_dwordx4 v[172:175], v107, s[8:11], s35 offen offset:3072 sc1
  s_lshl_b32 s29, s17, 3
  s_add_u32 s29, s29, 112
  s_mul_i32 s56, s38, 288
  s_add_u32 s56, s56, s29
  s_lshl_b32 s56, s56, 10
  s_add_u32 s56, s56, 7340032
  s_add_u32 s57, s56, 147456
  s_mul_i32 s58, s37, 288
  s_add_u32 s58, s58, s29
  s_lshl_b32 s58, s58, 10
  s_add_u32 s58, s58, 10485760
  s_add_u32 s59, s58, 147456
  buffer_load_dwordx4 v[176:179], v107, s[8:11], s56 offen offset:0 sc1
  buffer_load_dwordx4 v[180:183], v107, s[8:11], s57 offen offset:0 sc1
  buffer_load_dwordx4 v[184:187], v107, s[8:11], s56 offen offset:1024 sc1
  buffer_load_dwordx4 v[188:191], v107, s[8:11], s57 offen offset:1024 sc1
  buffer_load_dwordx4 v[192:195], v107, s[8:11], s56 offen offset:2048 sc1
  buffer_load_dwordx4 v[196:199], v107, s[8:11], s57 offen offset:2048 sc1
  buffer_load_dwordx4 v[200:203], v107, s[8:11], s56 offen offset:3072 sc1
  buffer_load_dwordx4 v[204:207], v107, s[8:11], s57 offen offset:3072 sc1
  s_add_u32 s56, s56, 4096
  s_add_u32 s57, s57, 4096
  buffer_load_dwordx4 v[208:211], v107, s[8:11], s56 offen offset:0 sc1
  buffer_load_dwordx4 v[212:215], v107, s[8:11], s57 offen offset:0 sc1
  buffer_load_dwordx4 v[216:219], v107, s[8:11], s56 offen offset:1024 sc1
  buffer_load_dwordx4 v[220:223], v107, s[8:11], s57 offen offset:1024 sc1
  buffer_load_dwordx4 v[224:227], v107, s[8:11], s56 offen offset:2048 sc1
  buffer_load_dwordx4 v[228:231], v107, s[8:11], s57 offen offset:2048 sc1
  buffer_load_dwordx4 v[232:235], v107, s[8:11], s56 offen offset:3072 sc1
  buffer_load_dwordx4 v[236:239], v107, s[8:11], s57 offen offset:3072 sc1
  v_lshrrev_b32 v241, 3, v244
  v_and_b32 v242, 7, v244
  v_lshlrev_b32 v245, 10, v241
  v_lshl_add_u32 v245, v242, 4, v245
  v_mul_u32_u24 v246, 272, v241
  v_lshl_add_u32 v246, v242, 5, v246
  s_bfe_u32 s28, s12, 0x20001
  s_lshl_b32 s37, s13, 2
  s_add_u32 s37, s37, s28
  s_and_b32 s28, s12, 1
  s_lshl_b32 s28, s28, 2
  s_lshr_b32 s30, s12, 3
  s_add_u32 s38, s28, s30
  s_lshl_b32 s39, s37, 16
  s_lshl_b32 s30, s38, 7
  s_add_u32 s39, s39, s30
  buffer_load_dwordx4 v[240:243], v245, s[44:47], s39 offen
  v_and_b32 v2, 31, v0
  v_lshrrev_b32 v3, 5, v0
  v_mul_u32_u24 v2, 272, v2
  v_lshl_add_u32 v2, v3, 4, v2
  s_mul_i32 s30, s17, 17408
  v_add_u32 v2, s30, v2
  s_barrier
  s_waitcnt vmcnt(0)
  v_mfma_f32_32x32x16_bf16 v[16:31], v[128:131], v[136:139], v[16:31]
  v_mfma_f32_32x32x16_bf16 v[32:47], v[128:131], v[140:143], v[32:47]
  v_mfma_f32_32x32x16_bf16 v[48:63], v[132:135], v[136:139], v[48:63]
  v_mfma_f32_32x32x16_bf16 v[64:79], v[132:135], v[140:143], v[64:79]
  v_mfma_f32_32x32x16_bf16 v[16:31], v[144:147], v[152:155], v[16:31]
  v_mfma_f32_32x32x16_bf16 v[32:47], v[144:147], v[156:159], v[32:47]
  v_mfma_f32_32x32x16_bf16 v[48:63], v[148:151], v[152:155], v[48:63]
  v_mfma_f32_32x32x16_bf16 v[64:79], v[148:151], v[156:159], v[64:79]
  v_mfma_f32_32x32x16_bf16 v[16:31], v[160:163], v[168:171], v[16:31]
  v_mfma_f32_32x32x16_bf16 v[32:47], v[160:163], v[172:175], v[32:47]
  v_mfma_f32_32x32x16_bf16 v[48:63], v[164:167], v[168:171], v[48:63]
  v_mfma_f32_32x32x16_bf16 v[64:79], v[164:167], v[172:175], v[64:79]
  s_bfe_u32 s28, s12, 0x20001
  s_lshl_b32 s29, s13, 2
  s_add_u32 s29, s29, s28
  s_lshl_b32 s29, s29, 7
  s_lshl_b32 s28, s17, 5
  s_add_u32 s29, s29, s28
  s_add_u32 s29, s29, 20971520
  v_and_b32 v7, 7, v0
  v_lshlrev_b32 v7, 2, v7
  s_mov_b32 s30, 0
att_gp:
  buffer_load_dword v5, v7, s[8:11], s29 offen sc1
  s_waitcnt vmcnt(0)
  v_cmp_eq_u32 vcc, s36, v5
  s_add_u32 s30, s30, 1
  s_cmp_gt_u32 s30, 200000
  s_cbranch_scc1 att_gpd
  s_cmp_eq_u64 vcc, exec
  s_cbranch_scc0 att_gp
att_gpd:
  buffer_load_dwordx4 v[112:115], v107, s[8:11], s58 offen offset:0 sc1
  buffer_load_dwordx4 v[116:119], v107, s[8:11], s59 offen offset:0 sc1
  buffer_load_dwordx4 v[120:123], v107, s[8:11], s58 offen offset:1024 sc1
  buffer_load_dwordx4 v[124:127], v107, s[8:11], s59 offen offset:1024 sc1
  buffer_load_dwordx4 v[128:131], v107, s[8:11], s58 offen offset:2048 sc1
  buffer_load_dwordx4 v[132:135], v107, s[8:11], s59 offen offset:2048 sc1
  buffer_load_dwordx4 v[136:139], v107, s[8:11], s58 offen offset:3072 sc1
  buffer_load_dwordx4 v[140:143], v107, s[8:11], s59 offen offset:3072 sc1
  s_add_u32 s58, s58, 4096
  s_add_u32 s59, s59, 4096
  buffer_load_dwordx4 v[144:147], v107, s[8:11], s58 offen offset:0 sc1
  buffer_load_dwordx4 v[148:151], v107, s[8:11], s59 offen offset:0 sc1
  buffer_load_dwordx4 v[152:155], v107, s[8:11], s58 offen offset:1024 sc1
  buffer_load_dwordx4 v[156:159], v107, s[8:11], s59 offen offset:1024 sc1
  buffer_load_dwordx4 v[160:163], v107, s[8:11], s58 offen offset:2048 sc1
  buffer_load_dwordx4 v[164:167], v107, s[8:11], s59 offen offset:2048 sc1
  buffer_load_dwordx4 v[168:171], v107, s[8:11], s58 offen offset:3072 sc1
  buffer_load_dwordx4 v[172:175], v107, s[8:11], s59 offen offset:3072 sc1
  s_waitcnt vmcnt(14)
  v_mfma_f32_32x32x16_bf16 v[16:31], v[176:179], v[112:115], v[16:31]
  v_mfma_f32_32x32x16_bf16 v[32:47], v[176:179], v[116:119], v[32:47]
  v_mfma_f32_32x32x16_bf16 v[48:63], v[180:183], v[112:115], v[48:63]
  v_mfma_f32_32x32x16_bf16 v[64:79], v[180:183], v[116:119], v[64:79]
  s_waitcnt vmcnt(12)
  v_mfma_f32_32x32x16_bf16 v[16:31], v[184:187], v[120:123], v[16:31]
  v_mfma_f32_32x32x16_bf16 v[32:47], v[184:187], v[124:127], v[32:47]
  v_mfma_f32_32x32x16_bf16 v[48:63], v[188:191], v[120:123], v[48:63]
  v_mfma_f32_32x32x16_bf16 v[64:79], v[188:191], v[124:127], v[64:79]
  s_waitcnt vmcnt(10)
  v_mfma_f32_32x32x16_bf16 v[16:31], v[192:195], v[128:131], v[16:31]
  v_mfma_f32_32x32x16_bf16 v[32:47], v[192:195], v[132:135], v[32:47]
  v_mfma_f32_32x32x16_bf16 v[48:63], v[196:199], v[128:131], v[48:63]
  v_mfma_f32_32x32x16_bf16 v[64:79], v[196:199], v[132:135], v[64:79]
  s_waitcnt vmcnt(8)
  v_mfma_f32_32x32x16_bf16 v[16:31], v[200:203], v[136:139], v[16:31]
  v_mfma_f32_32x32x16_bf16 v[32:47], v[200:203], v[140:143], v[32:47]
  v_mfma_f32_32x32x16_bf16 v[48:63], v[204:207], v[136:139], v[48:63]
  v_mfma_f32_32x32x16_bf16 v[64:79], v[204:207], v[140:143], v[64:79]
  s_waitcnt vmcnt(6)
  v_mfma_f32_32x32x16_bf16 v[16:31], v[208:211], v[144:147], v[16:31]
  v_mfma_f32_32x32x16_bf16 v[32:47], v[208:211], v[148:151], v[32:47]
  v_mfma_f32_32x32x16_bf16 v[48:63], v[212:215], v[144:147], v[48:63]
  v_mfma_f32_32x32x16_bf16 v[64:79], v[212:215], v[148:151], v[64:79]
  s_waitcnt vmcnt(4)
  v_mfma_f32_32x32x16_bf16 v[16:31], v[216:219], v[152:155], v[16:31]
  v_mfma_f32_32x32x16_bf16 v[32:47], v[216:219], v[156:159], v[32:47]
  v_mfma_f32_32x32x16_bf16 v[48:63], v[220:223], v[152:155], v[48:63]
  v_mfma_f32_32x32x16_bf16 v[64:79], v[220:223], v[156:159], v[64:79]
  s_waitcnt vmcnt(2)
  v_mfma_f32_32x32x16_bf16 v[16:31], v[224:227], v[160:163], v[16:31]
  v_mfma_f32_32x32x16_bf16 v[32:47], v[224:227], v[164:167], v[32:47]
  v_mfma_f32_32x32x16_bf16 v[48:63], v[228:231], v[160:163], v[48:63]
  v_mfma_f32_32x32x16_bf16 v[64:79], v[228:231], v[164:167], v[64:79]
  s_waitcnt vmcnt(0)
  v_mfma_f32_32x32x16_bf16 v[16:31], v[232:235], v[168:171], v[16:31]
  v_mfma_f32_32x32x16_bf16 v[32:47], v[232:235], v[172:175], v[32:47]
  v_mfma_f32_32x32x16_bf16 v[48:63], v[236:239], v[168:171], v[48:63]
  v_mfma_f32_32x32x16_bf16 v[64:79], v[236:239], v[172:175], v[64:79]
  s_nop 7
  s_nop 3
  ds_write_b128 v2, v[16:19] offset:0
  ds_write_b128 v2, v[20:23] offset:32
  ds_write_b128 v2, v[24:27] offset:64
  ds_write_b128 v2, v[28:31] offset:96
  ds_write_b128 v2, v[32:35] offset:8704
  ds_write_b128 v2, v[36:39] offset:8736
  ds_write_b128 v2, v[40:43] offset:8768
  ds_write_b128 v2, v[44:47] offset:8800
  ds_write_b128 v2, v[48:51] offset:128
  ds_write_b128 v2, v[52:55] offset:160
  ds_write_b128 v2, v[56:59] offset:192
  ds_write_b128 v2, v[60:63] offset:224
  ds_write_b128 v2, v[64:67] offset:8832
  ds_write_b128 v2, v[68:71] offset:8864
  ds_write_b128 v2, v[72:75] offset:8896
  ds_write_b128 v2, v[76:79] offset:8928
  s_waitcnt lgkmcnt(0)
  s_barrier
att_fin:
  ds_read_b128 v[16:19], v246 offset:0
  ds_read_b128 v[20:23], v246 offset:16
  ds_read_b128 v[24:27], v246 offset:17408
  ds_read_b128 v[28:31], v246 offset:17424
  ds_read_b128 v[32:35], v246 offset:34816
  ds_read_b128 v[36:39], v246 offset:34832
  ds_read_b128 v[40:43], v246 offset:52224
  ds_read_b128 v[44:47], v246 offset:52240
  s_waitcnt lgkmcnt(4)
  v_pk_add_f32 v[16:17], v[16:17], v[24:25]
  v_pk_add_f32 v[18:19], v[18:19], v[26:27]
  v_pk_add_f32 v[20:21], v[20:21], v[28:29]
  v_pk_add_f32 v[22:23], v[22:23], v[30:31]
  s_waitcnt lgkmcnt(0)
  v_pk_add_f32 v[16:17], v[16:17], v[32:33]
  v_pk_add_f32 v[18:19], v[18:19], v[34:35]
  v_pk_add_f32 v[20:21], v[20:21], v[36:37]
  v_pk_add_f32 v[22:23], v[22:23], v[38:39]
  v_pk_add_f32 v[16:17], v[16:17], v[40:41]
  v_pk_add_f32 v[18:19], v[18:19], v[42:43]
  v_pk_add_f32 v[20:21], v[20:21], v[44:45]
  v_pk_add_f32 v[22:23], v[22:23], v[46:47]
  s_waitcnt vmcnt(0)
  v_lshlrev_b32 v8, 16, v240
  v_and_b32 v9, 0xffff0000, v240
  v_pk_add_f32 v[16:17], v[16:17], v[8:9]
  v_lshlrev_b32 v8, 16, v241
  v_and_b32 v9, 0xffff0000, v241
  v_pk_add_f32 v[18:19], v[18:19], v[8:9]
  v_lshlrev_b32 v8, 16, v242
  v_and_b32 v9, 0xffff0000, v242
  v_pk_add_f32 v[20:21], v[20:21], v[8:9]
  v_lshlrev_b32 v8, 16, v243
  v_and_b32 v9, 0xffff0000, v243
  v_pk_add_f32 v[22:23], v[22:23], v[8:9]
  v_cvt_pk_bf16_f32 v16, v16, v17
  v_cvt_pk_bf16_f32 v17, v18, v19
  v_cvt_pk_bf16_f32 v18, v20, v21
  v_cvt_pk_bf16_f32 v19, v22, v23
  buffer_store_dwordx4 v[16:19], v245, s[48:51], s39 offen
  s_endpgm
k1_end:
  s_endpgm
.section .rodata,"a"
.p2align 6
.amdhsa_kernel parallel_sum__softmax_full_mha__dense_activation_mish__prompt_kernel
  .amdhsa_next_free_vgpr 256
  .amdhsa_next_free_sgpr 102
  .amdhsa_accum_offset 256
  .amdhsa_group_segment_fixed_size 0
  .amdhsa_kernarg_size 80
  .amdhsa_user_sgpr_count 2
  .amdhsa_user_sgpr_kernarg_segment_ptr 1
  .amdhsa_system_sgpr_workgroup_id_x 1
  .amdhsa_float_denorm_mode_32 3
.end_amdhsa_kernel
```
